```python
import torch

def _softmax(x, axis=-1):
    return torch.softmax(x, dim=axis)
def _gelu(x):
    return torch.nn.functional.gelu(x, approximate="tanh")
def _silu(x):
    return torch.nn.functional.silu(x)
def _sigmoid(x):
    return torch.sigmoid(x)
def _layernorm(x, axis=-1, eps=1e-5):
    m = x.mean(dim=axis, keepdim=True)
    v = x.var(dim=axis, keepdim=True, unbiased=False)
    return (x - m) / torch.sqrt(v + eps)
def _scatter_add(tgt, idx, src, axis=0):
    return tgt.clone().index_add_(axis, idx, src)
def _segment_sum(src, seg, n):
    out = torch.zeros((n,) + src.shape[1:], dtype=src.dtype)
    return out.index_add_(0, seg, src)
def _pad(x, pw):
    flat = tuple(v for pair in reversed(pw) for v in pair)
    return torch.nn.functional.pad(x, flat)

kernel_name = 'gated_mix__linear_kernel_hedgehog__ssm_conv_s5__prompt'

def setup_inputs():

    _w = (lambda a: (lambda t: t.to(torch.bfloat16) if t.is_floating_point() else t)(torch.as_tensor(a)))
    def _A_setup():
        B, S, D, H = 1, 2048, 512, 32
        Dh = D // H
        return {
            "x": _w((lambda *s: torch.randn(*s, dtype=torch.bfloat16) * 0.05)(B, S, D)),
            "wqkv": _w((lambda *s: torch.randn(*s, dtype=torch.bfloat16) * 1.6)(D, 3 * D)),
            "w_phi": _w((lambda *s: torch.randn(*s, dtype=torch.bfloat16) * 1.6)(H, Dh, Dh) * (Dh ** -0.5)),
            "wo": _w((lambda *s: torch.randn(*s, dtype=torch.bfloat16) * 0.05)(D, D)),
        }
    _A_in = _A_setup()

    def _B_setup():
        B, S, D = 1, 2048, 512
        P = D
        Lambda_re = -0.5 * (lambda _x: torch.exp(torch.as_tensor(_x)))((lambda *s: torch.randn(*s, dtype=torch.bfloat16) * 0.8)(P))
        Lambda_im = (lambda *s: torch.randn(*s, dtype=torch.bfloat16) * 0.8)(P) * 1.0
        B_re = (lambda *s: torch.randn(*s, dtype=torch.bfloat16) * 0.8)(P, D) * (D ** -0.5)
        B_im = (lambda *s: torch.randn(*s, dtype=torch.bfloat16) * 0.8)(P, D) * (D ** -0.5)
        C_re = (lambda *s: torch.randn(*s, dtype=torch.bfloat16) * 0.8)(D, P) * (P ** -0.5)
        C_im = (lambda *s: torch.randn(*s, dtype=torch.bfloat16) * 0.8)(D, P) * (P ** -0.5)
        log_dt = (lambda *s: torch.randn(*s, dtype=torch.bfloat16) * 0.8)(P) * 0.3 - 2.0
        Dskip = (lambda *s: torch.randn(*s, dtype=torch.bfloat16) * 0.8)(D)
        return {
            "x": _w((lambda *s: torch.randn(*s, dtype=torch.bfloat16) * 0.05)(B, S, D)),
            "Lambda_re": _w(Lambda_re),
            "Lambda_im": _w(Lambda_im),
            "B_re": _w(B_re),
            "B_im": _w(B_im),
            "C_re": _w(C_re),
            "C_im": _w(C_im),
            "log_dt": _w(log_dt),
            "Dskip": _w(Dskip),
        }
    _B_in = _B_setup()

    return {
        "A_x": _A_in["x"],
        "A_wqkv": _A_in["wqkv"],
        "A_w_phi": _A_in["w_phi"],
        "A_wo": _A_in["wo"],
        "B_x": _B_in["x"],
        "B_Lambda_re": _B_in["Lambda_re"],
        "B_Lambda_im": _B_in["Lambda_im"],
        "B_B_re": _B_in["B_re"],
        "B_B_im": _B_in["B_im"],
        "B_C_re": _B_in["C_re"],
        "B_C_im": _B_in["C_im"],
        "B_log_dt": _B_in["log_dt"],
        "B_Dskip": _B_in["Dskip"],
        "gate_w": _w((lambda *s: torch.randn(*s, dtype=torch.bfloat16) * 0.05)(512) * 16.0),
    }

def reference(A_x, A_wqkv, A_w_phi, A_wo, B_x, B_Lambda_re, B_Lambda_im, B_B_re, B_B_im, B_C_re, B_C_im, B_log_dt, B_Dskip, gate_w):
    def _A_ref(x, wqkv, w_phi, wo):
        B, S, D = x.shape
        H = 32; Dh = D // H
        qkv = (lambda x, *d: x.permute(*d))((x @ wqkv).reshape(B, S, 3, H, Dh), 2, 0, 3, 1, 4)
        q, k, v = qkv[0], qkv[1], qkv[2]
        pq = torch.einsum("bhsd,hdf->bhsf", q, w_phi)
        pk = torch.einsum("bhsd,hdf->bhsf", k, w_phi)
        phi_q = torch.concatenate([_softmax(pq, axis=-1), _softmax(-pq, axis=-1)], axis=-1)
        phi_k = torch.concatenate([_softmax(pk, axis=-1), _softmax(-pk, axis=-1)], axis=-1)
        kv = torch.einsum("bhsf,bhsd->bhfd", phi_k, v)
        z  = torch.einsum("bhsf->bhf", phi_k)
        num = torch.einsum("bhqf,bhfd->bhqd", phi_q, kv)
        den = torch.einsum("bhqf,bhf->bhq", phi_q, z)[..., None] + 1e-6
        o = num / den
        return (lambda x, *d: x.permute(*d))(o, 0, 2, 1, 3).reshape(B, S, D) @ wo

    def _B_ref(x, Lambda_re, Lambda_im, B_re, B_im, C_re, C_im, log_dt, Dskip):
        Bsz, L, H = x.shape
        Lam = Lambda_re + 1j * Lambda_im
        Bmat = B_re + 1j * B_im
        Cmat = C_re + 1j * C_im
        dt = torch.exp(log_dt)
        Lam_bar = torch.exp(dt * Lam)
        B_bar = ((Lam_bar - 1.0) / Lam)[:, None] * Bmat
        Bu = torch.einsum("bld,pd->blp", x + 0j, B_bar)
        h = torch.zeros_like(Bu[:, 0, :])
        hs = []
        for t in range(L):
            h = Lam_bar[None, :] * h + Bu[:, t, :]
            hs.append(h)
        hseq = torch.stack(hs, 1)
        y = 2.0 * torch.einsum("blp,dp->bld", hseq, Cmat).real + x * Dskip[None, None, :]
        return y

    x = A_x
    g = _sigmoid((x * gate_w).sum(-1, keepdims=True))
    a = _A_ref(x, A_wqkv, A_w_phi, A_wo)
    b = _B_ref(x, B_Lambda_re, B_Lambda_im, B_B_re, B_B_im, B_C_re, B_C_im, B_log_dt, B_Dskip)
    return g * a + (1 - g) * b
```

```asm
; @launch grid=(256,1,1) block=(256,1,1) lds=163840
.amdgcn_target "amdgcn-amd-amdhsa--gfx950"
.text
.globl gated_mix__linear_kernel_hedgehog__ssm_conv_s5__prompt_kernel
.p2align 8
.type gated_mix__linear_kernel_hedgehog__ssm_conv_s5__prompt_kernel,@function
gated_mix__linear_kernel_hedgehog__ssm_conv_s5__prompt_kernel:
    s_cmp_ge_u32 s2, 256
    s_cbranch_scc1 L_end
    s_load_dwordx16 s[4:19], s[0:1], 0
    s_load_dwordx16 s[20:35], s[0:1], 64
    s_load_dwordx2 s[36:37], s[0:1], 128
    s_getpc_b64 s[40:41]
L_pc:
    s_lshr_b32 s3, s2, 3
    s_and_b32 s3, s3, 7
    s_lshl_b32 s3, s3, 12
    v_and_b32 v1, 31, v0
    v_lshl_add_u32 v1, v1, 7, s3
    v_min_u32 v1, L_code_end-L_pc-4, v1
    global_load_dword v255, v1, s[40:41]
    s_and_b32 s95, s2, 7
    s_lshr_b32 s96, s2, 3
    v_lshrrev_b32 v3, 6, v0
    v_and_b32 v1, 63, v0
    v_readfirstlane_b32 s90, v3
    s_and_b32 s88, s95, 1
    s_lshl_b32 s92, s88, 4
    s_lshl_b32 s88, s88, 3
    s_and_b32 s93, s96, 7
    s_or_b32 s88, s88, s93
    s_lshr_b32 s89, s95, 1
    s_lshl_b32 s89, s89, 2
    s_lshr_b32 s96, s96, 3
    s_or_b32 s89, s89, s96
    s_or_b32 s92, s92, s89
    s_lshl_b32 s94, s88, 2
    s_or_b32 s94, s94, s90
    s_lshl_b32 s95, s89, 1
    s_add_u32 s95, s95, s88
    v_lshlrev_b32 v61, 4, v1
    v_lshrrev_b32_e64 v2, 5, v1
    s_add_u32 s98, s95, 0
    s_and_b32 s98, s98, 7
    s_lshl_b32 s72, s98, 7
    s_mul_i32 s80, s98, 196608
    s_add_u32 s98, s95, 1
    s_and_b32 s98, s98, 7
    s_lshl_b32 s73, s98, 7
    s_mul_i32 s81, s98, 196608
    s_add_u32 s98, s95, 2
    s_and_b32 s98, s98, 7
    s_lshl_b32 s74, s98, 7
    s_mul_i32 s82, s98, 196608
    s_add_u32 s98, s95, 3
    s_and_b32 s98, s98, 7
    s_lshl_b32 s75, s98, 7
    s_mul_i32 s83, s98, 196608
    s_add_u32 s98, s95, 4
    s_and_b32 s98, s98, 7
    s_lshl_b32 s76, s98, 7
    s_mul_i32 s84, s98, 196608
    s_add_u32 s98, s95, 5
    s_and_b32 s98, s98, 7
    s_lshl_b32 s77, s98, 7
    s_mul_i32 s85, s98, 196608
    s_add_u32 s98, s95, 6
    s_and_b32 s98, s98, 7
    s_lshl_b32 s78, s98, 7
    s_mul_i32 s86, s98, 196608
    s_add_u32 s98, s95, 7
    s_and_b32 s98, s98, 7
    s_lshl_b32 s79, s98, 7
    s_mul_i32 s87, s98, 196608
    v_lshrrev_b32 v3, 4, v1
    v_and_b32 v62, 7, v1
    v_xor_b32 v62, v62, v3
    v_lshlrev_b32 v62, 4, v62
    v_and_b32 v4, 1, v3
    v_and_b32 v5, 8, v1
    v_or_b32 v4, v4, v5
    v_lshl_or_b32 v4, v2, 4, v4
    s_lshl_b32 s98, s94, 5
    v_add_u32 v4, s98, v4
    v_lshl_or_b32 v4, v4, 10, v62
    v_xor_b32 v5, 64, v4
    v_add_u32 v5, 1024, v5
    v_add_u32 v6, 2048, v4
    v_add_u32 v7, 2048, v5
    s_and_b32 s98, s90, 1
    s_lshl_b32 s98, s98, 4
    s_lshl_b32 s3, s89, 5
    s_add_u32 s98, s98, s3
    v_lshrrev_b32 v3, 3, v1
    v_lshl_or_b32 v26, v3, 10, v62
    s_lshl_b32 s98, s98, 10
    v_add_u32 v8, s98, v26
    v_xor_b32 v9, 64, v8
    v_add_u32 v9, 7168, v9
    s_lshl_b32 s3, s90, 12
    s_lshl_b32 s96, s90, 11
    s_add_u32 s96, s96, 98304
    v_lshrrev_b32_e64 v3, 2, v1
    s_lshl_b32 s98, s90, 4
    v_add_u32_e64 v3, s98, v3
    v_mul_u32_u24 v11, 3072, v3
    v_and_b32_e64 v62, 3, v1
    s_lshl_b32 s98, s89, 6
    v_lshl_add_u32 v62, v62, 4, s98
    v_add_u32 v11, v11, v62
    v_and_b32_e64 v0, 31, v1
    s_lshl_b32 s98, s89, 6
    v_lshl_add_u32 v200, v0, 1, s98
    v_bfe_u32 v3, v1, 3, 2
    v_and_b32_e64 v62, 3, v1
    v_lshl_add_u32 v3, v3, 2, v62
    v_lshlrev_b32_e64 v3, 1, v3
    v_lshl_or_b32 v3, v2, 7, v3
    v_bfe_u32 v62, v1, 2, 1
    v_lshl_or_b32 v3, v62, 9, v3
    s_lshl_b32 s98, s89, 10
    v_add_u32_e64 v201, s98, v3
    v_lshlrev_b32_e64 v202, 21, v1
    v_and_b32 v202, 0x600000, v202
    s_lshl_b32 s98, s92, 17
    v_mov_b32_e64 v203, s98
    v_mov_b32 v204, 0
    s_lshl2_add_u32 s98, s2, s90
    v_and_b32_e64 v62, 3, v1
    s_lshl_b32 s100, s98, 9
    v_lshl_add_u32 v176, v62, 7, s100
    s_mov_b32 s46, 1572864
    s_mov_b32 s47, 0x20000
    s_mov_b32 s42, 2097152
    s_mov_b32 s43, 0x20000
    s_mov_b32 s50, 524288
    s_mov_b32 s51, 0x20000
    s_waitcnt lgkmcnt(0)
    s_mov_b32 s40, s4
    s_and_b32 s41, s5, 0xffff
    s_mov_b32 s34, s3
    s_mov_b32 s0, s96
    s_add_u32 m0, s34, 0
    s_nop 0
    buffer_load_dwordx4 v4, s[40:43], s72 offen offset:0 lds
    buffer_load_dwordx4 v5, s[40:43], s72 offen offset:1024 lds
    buffer_load_dwordx4 v6, s[40:43], s72 offen offset:2048 lds
    buffer_load_dwordx4 v7, s[40:43], s72 offen offset:3072 lds
    s_cmp_lt_u32 s90, 2
    s_cselect_b32 s48, s18, s20
    s_cselect_b32 s49, s19, s21
    s_and_b32 s49, s49, 0xffff
    s_add_u32 m0, s0, 0
    s_nop 0
    buffer_load_dwordx4 v8, s[48:51], s72 offen offset:0 lds
    buffer_load_dwordx4 v9, s[48:51], s72 offen offset:1024 lds
    global_load_ushort v160, v200, s[14:15]
    global_load_ushort v161, v200, s[16:17]
    global_load_ushort v162, v200, s[26:27]
    global_load_ushort v144, v201, s[8:9] offset:0
    global_load_ushort v145, v201, s[8:9] offset:32
    global_load_ushort v146, v201, s[8:9] offset:64
    global_load_ushort v147, v201, s[8:9] offset:96
    global_load_ushort v148, v201, s[8:9] offset:256
    global_load_ushort v149, v201, s[8:9] offset:288
    global_load_ushort v150, v201, s[8:9] offset:320
    global_load_ushort v151, v201, s[8:9] offset:352
    global_load_dwordx4 v[104:107], v61, s[30:31]
    global_load_dword v248, v61, s[28:29]
    global_load_dword v254, v202, s[36:37] offset:2048
    global_load_dword v252, v204, s[22:23]
    global_load_dword v251, v204, s[24:25]
    global_load_dword v250, v204, s[10:11]
    global_load_dword v249, v203, s[32:33]
    global_load_dword v253, v204, s[6:7]
    s_add_u32 m0, s34, 16384
    s_nop 0
    buffer_load_dwordx4 v4, s[40:43], s73 offen offset:0 lds
    buffer_load_dwordx4 v5, s[40:43], s73 offen offset:1024 lds
    buffer_load_dwordx4 v6, s[40:43], s73 offen offset:2048 lds
    buffer_load_dwordx4 v7, s[40:43], s73 offen offset:3072 lds
    s_mov_b32 s44, s6
    s_and_b32 s45, s7, 0xffff
    s_load_dword s91, s[36:37], 0
    s_mov_b32 s52, s22
    s_and_b32 s53, s23, 0xffff
    s_mov_b32 s54, 524288
    s_mov_b32 s55, 0x20000
    s_mov_b32 s56, s24
    s_and_b32 s57, s25, 0xffff
    s_mov_b32 s58, 524288
    s_mov_b32 s59, 0x20000
    s_mov_b32 s60, s10
    s_and_b32 s61, s11, 0xffff
    s_mov_b32 s62, 524288
    s_mov_b32 s63, 0x20000
    s_mov_b32 s64, s36
    s_and_b32 s65, s37, 0xffff
    s_mov_b32 s66, 268435456
    s_mov_b32 s67, 0x20000
    s_mov_b32 s68, s32
    s_and_b32 s69, s33, 0xffff
    s_mov_b32 s70, 4194304
    s_mov_b32 s71, 0x20000
    s_lshl_b32 s35, s90, 14
    s_add_u32 s35, s35, 98304
    s_mov_b32 s32, 0xffff0000
    s_mov_b32 s33, 0xffff
    s_mov_b32 s97, 0xff
    s_mov_b32 s38, 0x3fb8aa3b
    s_mov_b32 s39, 0x3fb8aa3b
    s_cmp_ge_u32 s90, 1
    s_cselect_b64 s[4:5], -1, 0
    s_cmp_ge_u32 s90, 2
    s_cselect_b64 s[6:7], -1, 0
    s_cmp_ge_u32 s90, 3
    s_cselect_b64 s[10:11], -1, 0
    s_mov_b32 s12, 0
    s_mov_b32 s13, -1
    s_add_u32 s98, s89, s93
    s_and_b32 s98, s98, 3
    s_lshl_b32 s95, s90, 2
    s_xor_b32 s96, s98, 0
    s_or_b32 s96, s96, s95
    s_lshl_b32 s22, s96, 15
    s_xor_b32 s96, s98, 1
    s_or_b32 s96, s96, s95
    s_lshl_b32 s23, s96, 15
    s_xor_b32 s96, s98, 2
    s_or_b32 s96, s96, s95
    s_lshl_b32 s24, s96, 15
    s_xor_b32 s96, s98, 3
    s_or_b32 s96, s96, s95
    s_lshl_b32 s25, s96, 15
    s_and_b32 s96, s98, 2
    s_or_b32 s96, s96, s95
    s_lshl_b32 s96, s96, 6
    s_and_b32 s3, s90, 1
    s_lshl_b32 s3, s3, 15
    s_or_b32 s18, s96, s3
    s_xor_b32 s19, s18, 32768
    s_xor_b32 s20, s18, 128
    s_xor_b32 s21, s19, 128
    s_and_b32 s98, s98, 1
    s_lshl_b32 s98, s98, 6
    s_lshl_b32 s3, s93, 16
    v_add_u32 v26, s3, v26
    v_xor_b32 v27, 64, v26
    v_add_u32 v27, 7168, v27
    v_add_u32 v28, 14336, v26
    v_add_u32 v29, 14336, v27
    v_bfe_u32 v3, v1, 1, 3
    v_xor_b32 v3, v3, v2
    v_lshlrev_b32 v3, 4, v3
    v_lshl_or_b32 v3, v0, 7, v3
    v_xor_b32 v62, 0, v3
    v_add_u32 v20, 98304, v62
    v_add_u32 v12, s34, v62
    v_xor_b32 v62, s98, v62
    v_add_u32 v16, s35, v62
    v_xor_b32_e64 v62, 32, v3
    v_add_u32 v21, 98304, v62
    v_add_u32 v13, s34, v62
    v_xor_b32 v62, s98, v62
    v_add_u32 v17, s35, v62
    v_xor_b32 v62, 64, v3
    v_add_u32 v22, 98304, v62
    v_add_u32 v14, s34, v62
    v_xor_b32 v62, s98, v62
    v_add_u32 v18, s35, v62
    v_xor_b32 v62, 96, v3
    v_add_u32 v23, 98304, v62
    v_add_u32 v15, s34, v62
    v_xor_b32 v62, s98, v62
    v_add_u32 v19, s35, v62
    v_bfe_u32 v3, v1, 2, 2
    v_lshl_or_b32 v3, v2, 3, v3
    v_lshlrev_b32 v25, 6, v3
    v_bfe_u32 v62, v1, 4, 1
    v_lshl_or_b32 v25, v62, 5, v25
    v_and_b32 v3, 3, v1
    v_lshl_or_b32 v25, v3, 3, v25
    v_add_u32 v24, 32768, v25
    s_and_b32 s95, s90, 1
    v_xor_b32 v3, s95, v62
    v_lshlrev_b32 v3, 2, v3
    v_and_b32 v62, 7, v1
    v_xor_b32 v3, v3, v62
    s_lshl_b32 s98, s93, 7
    v_lshl_add_u32 v3, v3, 4, s98
    v_lshrrev_b32_e64 v62, 3, v1
    v_lshl_add_u32 v30, v62, 10, v3
    v_add_u32 v31, 7168, v30
    v_add_u32 v32, 14336, v30
    v_add_u32 v33, 21504, v30
    v_bfe_u32 v3, v1, 2, 2
    v_lshl_or_b32 v3, v2, 4, v3
    v_lshlrev_b32 v3, 7, v3
    v_bfe_u32 v62, v1, 3, 1
    v_lshl_or_b32 v3, v62, 6, v3
    v_and_b32 v62, 63, v25
    v_or_b32 v3, v62, v3
    v_add_u32 v36, s35, v3
    v_xor_b32 v3, 64, v3
    v_add_u32 v37, s35, v3
    v_lshlrev_b32 v0, 3, v0
    v_lshl_or_b32 v10, v2, 8, v0
    v_add_u32 v0, 98304, v0
    s_lshl_b32 s98, s90, 8
    v_add_u32 v34, s98, v0
    v_and_b32 v3, 7, v1
    v_lshlrev_b32 v3, 2, v3
    v_add_u32 v35, 147456, v3
    s_lshl_b32 s14, s92, 2
    s_add_u32 s14, s14, s90
    s_lshl_b32 s14, s14, 7
    s_lshl_b32 s98, s89, 13
    s_lshl_b32 s3, s88, 8
    s_sub_u32 s98, s98, s3
    s_add_u32 s36, s98, 20224
    s_lshl_b32 s98, s89, 2
    s_add_u32 s98, s98, s90
    s_lshl_b32 s37, s98, 14
    s_add_u32 s37, s37, 196608
    s_lshl_b32 s98, s88, 10
    s_add_u32 s1, s98, s37
    s_lshr_b32 s98, s94, 3
    s_lshl_b32 s98, s98, 19
    s_lshl_b32 s96, s89, 15
    s_add_u32 s98, s98, s96
    s_and_b32 s3, s94, 7
    s_lshl_b32 s3, s3, 12
    s_add_u32 s98, s98, s3
    s_add_u32 s15, s98, 2097152
    s_lshr_b32 s98, s94, 4
    s_lshl_b32 s98, s98, 19
    s_add_u32 s98, s98, s96
    s_and_b32 s3, s94, 15
    s_lshl_b32 s3, s3, 11
    s_add_u32 s98, s98, s3
    s_add_u32 s16, s98, 6291456
    s_lshr_b32 s96, s90, 1
    s_lshl_b32 s98, s92, 1
    s_or_b32 s26, s98, s96
    s_lshl_b32 s98, s94, 5
    s_lshl_b32 s3, s89, 1
    s_add_u32 s98, s98, s3
    s_lshl_b32 s27, s98, 10
    s_waitcnt lgkmcnt(0)
    s_add_u32 s91, s91, 1
    v_mov_b32_e64 v60, s91
    s_waitcnt vmcnt(23)
    s_barrier
    s_add_u32 m0, s0, 8192
    ds_read_b128 a[128:131], v12 offset:0
    buffer_load_dwordx4 v8, s[48:51], s73 offen offset:0 lds
    buffer_load_dwordx4 v9, s[48:51], s73 offen offset:1024 lds
    ds_read_b128 v[192:195], v20 offset:0
    s_add_u32 m0, s34, 32768
    ds_read_b128 v[196:199], v20 offset:4096
    buffer_load_dwordx4 v4, s[40:43], s74 offen offset:0 lds
    buffer_load_dwordx4 v5, s[40:43], s74 offen offset:1024 lds
    ds_read_b128 a[132:135], v13 offset:0
    buffer_load_dwordx4 v6, s[40:43], s74 offen offset:2048 lds
    ds_read_b128 v[200:203], v21 offset:0
    buffer_load_dwordx4 v7, s[40:43], s74 offen offset:3072 lds
    ds_read_b128 v[204:207], v21 offset:4096
    ds_read_b128 a[136:139], v14 offset:0
    s_add_u32 m0, s0, 16384
    ds_read_b128 v[208:211], v22 offset:0
    buffer_load_dwordx4 v8, s[48:51], s74 offen offset:0 lds
    buffer_load_dwordx4 v9, s[48:51], s74 offen offset:1024 lds
    ds_read_b128 v[212:215], v22 offset:4096
    ds_read_b128 a[140:143], v15 offset:0
    ds_read_b128 v[216:219], v23 offset:0
    ds_read_b128 v[220:223], v23 offset:4096
    s_waitcnt lgkmcnt(6)
    v_mfma_f32_32x32x16_bf16 v[64:79], a[128:131], v[192:195], 0
    s_waitcnt vmcnt(30)
    v_lshlrev_b32 v160, 16, v160
    s_waitcnt vmcnt(29)
    v_lshlrev_b32 v161, 16, v161
    s_waitcnt vmcnt(28)
    v_lshlrev_b32 v162, 16, v162
    v_mul_f32 v162, s38, v162
    v_mfma_f32_32x32x16_bf16 v[80:95], a[128:131], v[196:199], 0
    v_exp_f32 v162, v162
    v_mul_f32 v168, v160, v160
    v_fma_f32 v168, v161, v161, v168
    v_cvt_pk_bf16_f32 v162, v162, v162
    v_mfma_f32_32x32x16_bf16 v[64:79], a[132:135], v[200:203], v[64:79]
    v_and_b32 v162, s32, v162
    v_mul_f32 v164, v162, v160
    v_mul_f32 v165, v162, v161
    v_mul_f32 v164, s38, v164
    v_mfma_f32_32x32x16_bf16 v[80:95], a[132:135], v[204:207], v[80:95]
    v_mul_f32 v165, 0.15915494, v165
    v_exp_f32 v164, v164
    v_cos_f32 v166, v165
    v_sin_f32 v167, v165
    v_rcp_f32 v170, v168
    v_mul_f32 v38, v164, v166
    v_mul_f32 v39, v164, v167
    v_add_f32 v166, -1.0, v38
    v_mul_f32 v168, v166, v160
    v_fma_f32 v168, v39, v161, v168
    v_mul_f32 v169, v39, v160
    v_fma_f32 v169, -v166, v161, v169
    v_mul_f32_e64 v50, v168, v170
    v_mul_f32 v51, v169, v170
    s_waitcnt vmcnt(6)
    s_barrier
    s_add_u32 m0, s34, 49152
    s_waitcnt lgkmcnt(0)
    v_mfma_f32_32x32x16_bf16 v[64:79], a[136:139], v[208:211], v[64:79]
    buffer_load_dwordx4 v4, s[40:43], s75 offen offset:0 lds
    buffer_load_dwordx4 v5, s[40:43], s75 offen offset:1024 lds
    ds_read_b128 a[144:147], v12 offset:16384
    buffer_load_dwordx4 v6, s[40:43], s75 offen offset:2048 lds
    ds_read_b128 v[224:227], v20 offset:8192
    buffer_load_dwordx4 v7, s[40:43], s75 offen offset:3072 lds
    ds_read_b128 v[228:231], v20 offset:12288
    s_add_u32 m0, s0, 24576
    v_mfma_f32_32x32x16_bf16 v[80:95], a[136:139], v[212:215], v[80:95]
    buffer_load_dwordx4 v8, s[48:51], s75 offen offset:0 lds
    ds_read_b128 a[148:151], v13 offset:16384
    buffer_load_dwordx4 v9, s[48:51], s75 offen offset:1024 lds
    ds_read_b128 v[232:235], v21 offset:8192
    ds_read_b128 v[236:239], v21 offset:12288
    v_mfma_f32_32x32x16_bf16 v[64:79], a[140:143], v[216:219], v[64:79]
    buffer_load_dwordx4 v[96:99], v61, s[40:43], s27 offen
    ds_read_b128 a[152:155], v14 offset:16384
    ds_read_b128 v[240:243], v22 offset:8192
    ds_read_b128 v[244:247], v22 offset:12288
    v_mfma_f32_32x32x16_bf16 v[80:95], a[140:143], v[220:223], v[80:95]
    buffer_load_dwordx4 v[100:103], v61, s[40:43], s27 offen offset:1024
    ds_read_b128 a[156:159], v15 offset:16384
    ds_read_b128 v[248:251], v23 offset:8192
    ds_read_b128 v[252:255], v23 offset:12288
    s_add_u32 m0, s34, 65536
    s_waitcnt lgkmcnt(6)
    v_mfma_f32_32x32x16_bf16 v[64:79], a[144:147], v[224:227], v[64:79]
    buffer_load_dwordx4 v4, s[40:43], s76 offen offset:0 lds
    v_mul_f32 v164, v38, v38
    v_mul_f32 v165, v38, v39
    v_fma_f32 v164, -v39, v39, v164
    v_fma_f32 v165, v39, v38, v165
    v_mfma_f32_32x32x16_bf16 v[80:95], a[144:147], v[228:231], v[80:95]
    v_mul_f32 v166, v164, v164
    v_mul_f32_e64 v167, v164, v165
    v_fma_f32 v166, -v165, v165, v166
    v_fma_f32 v167, v165, v164, v167
    buffer_load_dwordx4 v5, s[40:43], s76 offen offset:1024 lds
    v_mfma_f32_32x32x16_bf16 v[64:79], a[148:151], v[232:235], v[64:79]
    v_mul_f32 v40, v166, v166
    v_mul_f32 v41, v166, v167
    v_fma_f32 v40, -v167, v167, v40
    v_fma_f32 v41, v167, v166, v41
    v_mfma_f32_32x32x16_bf16 v[80:95], a[148:151], v[236:239], v[80:95]
    v_mul_f32 v42, v40, v40
    v_mul_f32 v43, v40, v41
    v_fma_f32 v42, -v41, v41, v42
    v_fma_f32 v43, v41, v40, v43
    v_mul_f32 v44, v42, v42
    v_mul_f32 v45, v42, v43
    v_fma_f32 v44, -v43, v43, v44
    v_fma_f32 v45, v43, v42, v45
    v_mul_f32_e64 v164, v44, v44
    v_mul_f32_e64 v165, v44, v45
    v_fma_f32 v164, -v45, v45, v164
    v_fma_f32 v165, v45, v44, v165
    v_mul_f32_e64 v166, v164, v44
    v_mul_f32 v167, v164, v45
    v_fma_f32 v166, -v165, v45, v166
    v_fma_f32 v167, v165, v44, v167
    s_waitcnt vmcnt(10)
    s_barrier
    s_waitcnt lgkmcnt(0)
    v_mfma_f32_32x32x16_bf16 v[64:79], a[152:155], v[240:243], v[64:79]
    ds_read_b128 a[160:163], v12 offset:32768
    buffer_load_dwordx4 v6, s[40:43], s76 offen offset:2048 lds
    ds_read_b128 v[192:195], v20 offset:16384
    ds_read_b128 v[196:199], v20 offset:20480
    v_mfma_f32_32x32x16_bf16 v[80:95], a[152:155], v[244:247], v[80:95]
    ds_read_b128 a[164:167], v13 offset:32768
    buffer_load_dwordx4 v7, s[40:43], s76 offen offset:3072 lds
    ds_read_b128 v[200:203], v21 offset:16384
    ds_read_b128 v[204:207], v21 offset:20480
    v_mfma_f32_32x32x16_bf16 v[64:79], a[156:159], v[248:251], v[64:79]
    s_add_u32 m0, s0, 32768
    ds_read_b128 a[168:171], v14 offset:32768
    buffer_load_dwordx4 v8, s[48:51], s76 offen offset:0 lds
    ds_read_b128 v[208:211], v22 offset:16384
    ds_read_b128 v[212:215], v22 offset:20480
    buffer_load_dwordx4 v9, s[48:51], s76 offen offset:1024 lds
    v_mfma_f32_32x32x16_bf16 v[80:95], a[156:159], v[252:255], v[80:95]
    ds_read_b128 a[172:175], v15 offset:32768
    ds_read_b128 v[216:219], v23 offset:16384
    ds_read_b128 v[220:223], v23 offset:20480
    s_add_u32 m0, s34, 81920
    s_waitcnt lgkmcnt(5)
    v_mfma_f32_32x32x16_bf16 v[64:79], a[160:163], v[192:195], v[64:79]
    buffer_load_dwordx4 v4, s[40:43], s77 offen offset:0 lds
    v_mul_f32 v46, v164, v164
    v_mul_f32_e64 v47, v164, v165
    v_fma_f32 v46, -v165, v165, v46
    v_fma_f32 v47, v165, v164, v47
    v_mfma_f32_32x32x16_bf16 v[80:95], a[160:163], v[196:199], v[80:95]
    v_mul_f32 v48, v46, v46
    v_mul_f32 v49, v46, v47
    v_fma_f32 v48, -v47, v47, v48
    buffer_load_dwordx4 v5, s[40:43], s77 offen offset:1024 lds
    v_fma_f32 v49, v47, v46, v49
    v_mfma_f32_32x32x16_bf16 v[64:79], a[164:167], v[200:203], v[64:79]
    v_cndmask_b32 v168, 1.0, v44, s[4:5]
    v_cndmask_b32 v169, 0, v45, s[4:5]
    v_cndmask_b32 v168, v168, v164, s[6:7]
    v_cndmask_b32 v169, v169, v165, s[6:7]
    v_mfma_f32_32x32x16_bf16 v[80:95], a[164:167], v[204:207], v[80:95]
    v_cndmask_b32 v168, v168, v166, s[10:11]
    v_cndmask_b32 v169, v169, v167, s[10:11]
    v_mul_f32_e64 v170, v168, v42
    buffer_load_dwordx4 v6, s[40:43], s77 offen offset:2048 lds
    v_mul_f32_e64 v171, v168, v43
    v_fma_f32 v170, -v169, v43, v170
    v_fma_f32 v171, v169, v42, v171
    v_cndmask_b32 v188, v168, v170, s[12:13]
    v_cndmask_b32 v190, v169, v171, s[12:13]
    v_mul_f32 v189, v188, v40
    v_mul_f32_e64 v191, v188, v41
    v_fma_f32 v189, -v190, v41, v189
    v_fma_f32 v191, v190, v40, v191
    s_waitcnt vmcnt(11)
    s_barrier
    buffer_load_dwordx4 v7, s[40:43], s77 offen offset:3072 lds
    s_waitcnt lgkmcnt(0)
    v_mfma_f32_32x32x16_bf16 v[64:79], a[168:171], v[208:211], v[64:79]
    ds_read_b128 a[176:179], v12 offset:49152
    ds_read_b128 v[224:227], v20 offset:24576
    ds_read_b128 v[228:231], v20 offset:28672
    s_add_u32 m0, s0, 40960
    v_mfma_f32_32x32x16_bf16 v[80:95], a[168:171], v[212:215], v[80:95]
    buffer_load_dwordx4 v8, s[48:51], s77 offen offset:0 lds
    ds_read_b128 a[180:183], v13 offset:49152
    ds_read_b128 v[232:235], v21 offset:24576
    ds_read_b128 v[236:239], v21 offset:28672
    buffer_load_dwordx4 v9, s[48:51], s77 offen offset:1024 lds
    v_mfma_f32_32x32x16_bf16 v[64:79], a[172:175], v[216:219], v[64:79]
    ds_read_b128 a[184:187], v14 offset:49152
    ds_read_b128 v[240:243], v22 offset:24576
    s_add_u32 m0, s34, 0
    ds_read_b128 v[244:247], v22 offset:28672
    buffer_load_dwordx4 v4, s[40:43], s78 offen offset:0 lds
    v_mfma_f32_32x32x16_bf16 v[80:95], a[172:175], v[220:223], v[80:95]
    ds_read_b128 a[188:191], v15 offset:49152
    ds_read_b128 v[248:251], v23 offset:24576
    buffer_load_dwordx4 v5, s[40:43], s78 offen offset:1024 lds
    ds_read_b128 v[252:255], v23 offset:28672
    s_waitcnt lgkmcnt(5)
    v_mfma_f32_32x32x16_bf16 v[64:79], a[176:179], v[224:227], v[64:79]
    s_mov_b32 s100, 0xf0f0f0f0
    s_mov_b32 s101, 0xf0f0f0f0
    v_lshl_or_b32 v52, v145, 16, v144
    v_lshl_or_b32 v53, v147, 16, v146
    v_mfma_f32_32x32x16_bf16 v[80:95], a[176:179], v[228:231], v[80:95]
    buffer_load_dwordx4 v6, s[40:43], s78 offen offset:2048 lds
    v_lshl_or_b32 v54, v149, 16, v148
    v_lshl_or_b32 v55, v151, 16, v150
    v_cndmask_b32 v56, 0, v52, s[100:101]
    v_cndmask_b32 v52, v52, 0, s[100:101]
    v_mfma_f32_32x32x16_bf16 v[64:79], a[180:183], v[232:235], v[64:79]
    v_cndmask_b32 v57, 0, v53, s[100:101]
    v_cndmask_b32 v53, v53, 0, s[100:101]
    v_cndmask_b32 v58, 0, v54, s[100:101]
    v_cndmask_b32 v54, v54, 0, s[100:101]
    v_mfma_f32_32x32x16_bf16 v[80:95], a[180:183], v[236:239], v[80:95]
    buffer_load_dwordx4 v7, s[40:43], s78 offen offset:3072 lds
    v_cndmask_b32 v59, 0, v55, s[100:101]
    v_cndmask_b32 v55, v55, 0, s[100:101]
    v_add_u32 v12, 65536, v12
    v_add_u32 v13, 65536, v13
    v_add_u32 v14, 65536, v14
    v_add_u32 v15, 65536, v15
    s_waitcnt vmcnt(10)
    s_barrier
    s_waitcnt lgkmcnt(0)
    v_mfma_f32_32x32x16_bf16 v[64:79], a[184:187], v[240:243], v[64:79]
    s_add_u32 m0, s0, 49152
    ds_read_b128 a[192:195], v12 offset:0
    buffer_load_dwordx4 v8, s[48:51], s78 offen offset:0 lds
    ds_read_b128 v[192:195], v20 offset:32768
    ds_read_b128 v[196:199], v20 offset:36864
    buffer_load_dwordx4 v9, s[48:51], s78 offen offset:1024 lds
    v_mfma_f32_32x32x16_bf16 v[80:95], a[184:187], v[244:247], v[80:95]
    ds_read_b128 a[196:199], v13 offset:0
    ds_read_b128 v[200:203], v21 offset:32768
    ds_read_b128 v[204:207], v21 offset:36864
    s_add_u32 m0, s34, 16384
    v_mfma_f32_32x32x16_bf16 v[64:79], a[188:191], v[248:251], v[64:79]
    buffer_load_dwordx4 v4, s[40:43], s79 offen offset:0 lds
    ds_read_b128 a[200:203], v14 offset:0
    ds_read_b128 v[208:211], v22 offset:32768
    buffer_load_dwordx4 v5, s[40:43], s79 offen offset:1024 lds
    ds_read_b128 v[212:215], v22 offset:36864
    v_mfma_f32_32x32x16_bf16 v[80:95], a[188:191], v[252:255], v[80:95]
    ds_read_b128 a[204:207], v15 offset:0
    ds_read_b128 v[216:219], v23 offset:32768
    buffer_load_dwordx4 v6, s[40:43], s79 offen offset:2048 lds
    ds_read_b128 v[220:223], v23 offset:36864
    s_waitcnt lgkmcnt(6)
    v_mfma_f32_32x32x16_bf16 v[64:79], a[192:195], v[192:195], v[64:79]
    s_lshl2_add_u32 s98, s89, s90
    s_lshl_b32 s9, s98, 10
    s_add_u32 s9, s9, 1245184
    s_lshl_b32 s3, s88, 6
    v_mfma_f32_32x32x16_bf16 v[80:95], a[192:195], v[196:199], v[80:95]
    buffer_load_dwordx4 v7, s[40:43], s79 offen offset:3072 lds
    s_add_u32 s17, s3, s9
    s_lshr_b32 s8, s94, 1
    s_lshl_b32 s8, s8, 2
    s_lshr_b32 s3, s89, 2
    v_mfma_f32_32x32x16_bf16 v[64:79], a[196:199], v[200:203], v[64:79]
    s_add_u32 s8, s8, s3
    s_lshl_b32 s8, s8, 7
    s_and_b32 s3, s94, 1
    s_lshl_b32 s3, s3, 4
    v_mfma_f32_32x32x16_bf16 v[80:95], a[196:199], v[204:207], v[80:95]
    s_add_u32 m0, s0, 57344
    s_add_u32 s8, s8, s3
    buffer_load_dwordx4 v8, s[48:51], s79 offen offset:0 lds
    s_and_b32 s3, s89, 3
    s_lshl_b32 s3, s3, 2
    s_add_u32 s8, s8, s3
    s_waitcnt vmcnt(11)
    s_barrier
    s_waitcnt lgkmcnt(0)
    v_mfma_f32_32x32x16_bf16 v[64:79], a[200:203], v[208:211], v[64:79]
    ds_read_b128 a[208:211], v12 offset:16384
    buffer_load_dwordx4 v9, s[48:51], s79 offen offset:1024 lds
    ds_read_b128 v[224:227], v20 offset:40960
    ds_read_b128 v[228:231], v20 offset:45056
    v_mfma_f32_32x32x16_bf16 v[80:95], a[200:203], v[212:215], v[80:95]
    s_add_u32 m0, s34, 31744
    ds_read_b128 a[212:215], v13 offset:16384
    buffer_load_dwordx4 v11, s[44:47], s80 offen offset:1024 lds
    ds_read_b128 v[232:235], v21 offset:40960
    ds_read_b128 v[236:239], v21 offset:45056
    buffer_load_dwordx4 v11, s[44:47], s80 offen offset:2048 lds
    v_mfma_f32_32x32x16_bf16 v[64:79], a[204:207], v[216:219], v[64:79]
    ds_read_b128 a[216:219], v14 offset:16384
    ds_read_b128 v[240:243], v22 offset:40960
    ds_read_b128 v[244:247], v22 offset:45056
    v_mfma_f32_32x32x16_bf16 v[80:95], a[204:207], v[220:223], v[80:95]
    ds_read_b128 a[220:223], v15 offset:16384
    ds_read_b128 v[248:251], v23 offset:40960
    ds_read_b128 v[252:255], v23 offset:45056
    buffer_load_dword v181, v176, s[52:55], 0 offen
    s_waitcnt lgkmcnt(6)
    v_mfma_f32_32x32x16_bf16 v[64:79], a[208:211], v[224:227], v[64:79]
    v_lshlrev_b32 v108, 16, v104
    v_and_b32 v109, s32, v104
    v_lshlrev_b32 v110, 16, v105
    v_and_b32 v111, s32, v105
    v_mfma_f32_32x32x16_bf16 v[80:95], a[208:211], v[228:231], v[80:95]
    v_lshlrev_b32 v112, 16, v106
    v_and_b32 v113, s32, v106
    v_lshlrev_b32 v114, 16, v107
    v_and_b32 v115, s32, v107
    v_mfma_f32_32x32x16_bf16 v[64:79], a[212:215], v[232:235], v[64:79]
    v_lshlrev_b32 v116, 16, v96
    v_and_b32 v117, s32, v96
    v_lshlrev_b32 v118, 16, v97
    v_and_b32 v119, s32, v97
    v_mfma_f32_32x32x16_bf16 v[80:95], a[212:215], v[236:239], v[80:95]
    v_lshlrev_b32 v120, 16, v98
    v_and_b32 v121, s32, v98
    v_lshlrev_b32 v122, 16, v99
    buffer_load_dword v182, v176, s[56:59], 0 offen
    v_and_b32_e64 v123, s32, v99
    v_pk_mul_f32 v[116:117], v[116:117], v[108:109]
    v_pk_mul_f32 v[118:119], v[118:119], v[110:111]
    v_pk_mul_f32 v[120:121], v[120:121], v[112:113]
    v_pk_mul_f32 v[122:123], v[122:123], v[114:115]
    v_cvt_pk_bf16_f32 v124, v116, v117
    v_cvt_pk_bf16_f32 v125, v118, v119
    v_cvt_pk_bf16_f32 v126, v120, v121
    v_cvt_pk_bf16_f32 v127, v122, v123
    v_lshlrev_b32 v116, 16, v124
    v_and_b32 v117, s32, v124
    v_lshlrev_b32 v118, 16, v125
    v_and_b32 v119, s32, v125
    v_lshlrev_b32 v120, 16, v126
    v_and_b32 v121, s32, v126
    buffer_load_dword v183, v176, s[60:63], 0 offen
    v_lshlrev_b32_e64 v122, 16, v127
    v_and_b32_e64 v123, s32, v127
    v_pk_add_f32 v[116:117], v[116:117], v[118:119]
    s_add_u32 m0, s34, 33792
    v_pk_add_f32 v[120:121], v[120:121], v[122:123]
    buffer_load_dwordx4 v11, s[44:47], s81 offen offset:1024 lds
    v_pk_add_f32 v[116:117], v[116:117], v[120:121]
    v_add_f32 v128, v116, v117
    v_add_u32 v12, -65536, v12
    v_add_u32 v13, -65536, v13
    v_add_u32 v14, -65536, v14
    v_add_u32 v15, -65536, v15
    s_waitcnt vmcnt(12)
    s_barrier
    buffer_load_dwordx4 v11, s[44:47], s81 offen offset:2048 lds
    s_waitcnt lgkmcnt(0)
    v_mfma_f32_32x32x16_bf16 v[64:79], a[216:219], v[240:243], v[64:79]
    ds_read_b128 a[224:227], v12 offset:0
    ds_read_b128 v[192:195], v20 offset:49152
    ds_read_b128 v[196:199], v20 offset:53248
    v_mfma_f32_32x32x16_bf16 v[80:95], a[216:219], v[244:247], v[80:95]
    ds_read_b128 a[228:231], v13 offset:0
    ds_read_b128 v[200:203], v21 offset:49152
    ds_read_b128 v[204:207], v21 offset:53248
    s_add_u32 m0, s34, 48128
    v_mfma_f32_32x32x16_bf16 v[64:79], a[220:223], v[248:251], v[64:79]
    buffer_load_dwordx4 v11, s[44:47], s82 offen offset:1024 lds
    ds_read_b128 a[232:235], v14 offset:0
    ds_read_b128 v[208:211], v22 offset:49152
    ds_read_b128 v[212:215], v22 offset:53248
    v_mfma_f32_32x32x16_bf16 v[80:95], a[220:223], v[252:255], v[80:95]
    ds_read_b128 a[236:239], v15 offset:0
    ds_read_b128 v[216:219], v23 offset:49152
    buffer_load_dwordx4 v11, s[44:47], s82 offen offset:2048 lds
    ds_read_b128 v[220:223], v23 offset:53248
    s_waitcnt lgkmcnt(6)
    v_mfma_f32_32x32x16_bf16 v[64:79], a[224:227], v[192:195], v[64:79]
    v_lshlrev_b32 v116, 16, v100
    v_and_b32 v117, s32, v100
    v_lshlrev_b32 v118, 16, v101
    v_and_b32 v119, s32, v101
    v_mfma_f32_32x32x16_bf16 v[80:95], a[224:227], v[196:199], v[80:95]
    v_lshlrev_b32 v120, 16, v102
    v_and_b32 v121, s32, v102
    v_lshlrev_b32 v122, 16, v103
    v_and_b32_e64 v123, s32, v103
    v_mfma_f32_32x32x16_bf16 v[64:79], a[228:231], v[200:203], v[64:79]
    v_pk_mul_f32 v[116:117], v[116:117], v[108:109]
    v_pk_mul_f32 v[118:119], v[118:119], v[110:111]
    v_pk_mul_f32 v[120:121], v[120:121], v[112:113]
    v_pk_mul_f32 v[122:123], v[122:123], v[114:115]
    v_mfma_f32_32x32x16_bf16 v[80:95], a[228:231], v[204:207], v[80:95]
    s_add_u32 m0, s34, 50176
    v_cvt_pk_bf16_f32 v124, v116, v117
    buffer_load_dwordx4 v11, s[44:47], s83 offen offset:1024 lds
    v_cvt_pk_bf16_f32 v125, v118, v119
    v_cvt_pk_bf16_f32 v126, v120, v121
    v_cvt_pk_bf16_f32 v127, v122, v123
    v_lshlrev_b32_e64 v116, 16, v124
    v_and_b32_e64 v117, s32, v124
    v_lshlrev_b32_e64 v118, 16, v125
    v_and_b32_e64 v119, s32, v125
    v_lshlrev_b32_e64 v120, 16, v126
    v_and_b32_e64 v121, s32, v126
    v_lshlrev_b32_e64 v122, 16, v127
    v_and_b32_e64 v123, s32, v127
    v_pk_add_f32 v[116:117], v[116:117], v[118:119]
    v_pk_add_f32 v[120:121], v[120:121], v[122:123]
    v_pk_add_f32 v[116:117], v[116:117], v[120:121]
    v_add_f32 v130, v116, v117
    s_waitcnt vmcnt(10)
    s_barrier
    s_waitcnt lgkmcnt(0)
    v_mfma_f32_32x32x16_bf16 v[64:79], a[232:235], v[208:211], v[64:79]
    ds_read_b128 a[240:243], v12 offset:16384
    ds_read_b128 v[224:227], v20 offset:57344
    ds_read_b128 v[228:231], v20 offset:61440
    v_mfma_f32_32x32x16_bf16 v[80:95], a[232:235], v[212:215], v[80:95]
    ds_read_b128 a[244:247], v13 offset:16384
    ds_read_b128 v[232:235], v21 offset:57344
    ds_read_b128 v[236:239], v21 offset:61440
    v_mfma_f32_32x32x16_bf16 v[64:79], a[236:239], v[216:219], v[64:79]
    ds_read_b128 a[248:251], v14 offset:16384
    ds_read_b128 v[240:243], v22 offset:57344
    ds_read_b128 v[244:247], v22 offset:61440
    v_mfma_f32_32x32x16_bf16 v[80:95], a[236:239], v[220:223], v[80:95]
    ds_read_b128 a[252:255], v15 offset:16384
    ds_read_b128 v[248:251], v23 offset:57344
    ds_read_b128 v[252:255], v23 offset:61440
    s_waitcnt lgkmcnt(6)
    v_mfma_f32_32x32x16_bf16 v[64:79], a[240:243], v[224:227], v[64:79]
    v_mfma_f32_32x32x16_bf16 v[80:95], a[240:243], v[228:231], v[80:95]
    v_mfma_f32_32x32x16_bf16 v[64:79], a[244:247], v[232:235], v[64:79]
    v_mfma_f32_32x32x16_bf16 v[80:95], a[244:247], v[236:239], v[80:95]
    s_waitcnt lgkmcnt(4)
    v_mfma_f32_32x32x16_bf16 v[64:79], a[248:251], v[240:243], v[64:79]
    s_waitcnt lgkmcnt(3)
    v_mfma_f32_32x32x16_bf16 v[80:95], a[248:251], v[244:247], v[80:95]
    s_waitcnt lgkmcnt(1)
    v_mfma_f32_32x32x16_bf16 v[64:79], a[252:255], v[248:251], v[64:79]
    s_waitcnt lgkmcnt(0)
    v_mfma_f32_32x32x16_bf16 v[80:95], a[252:255], v[252:255], v[80:95]
    s_nop 9
    v_pk_mul_f32 v[192:193], v[64:65], v[50:51] op_sel:[0,1] op_sel_hi:[1,1]
    v_pk_mul_f32 v[64:65], v[64:65], v[50:51] op_sel:[0,0] op_sel_hi:[1,0]
    v_pk_fma_f32 v[64:65], v[80:81], v[50:51], v[64:65] op_sel:[0,1,0] op_sel_hi:[1,1,1] neg_lo:[0,1,0] neg_hi:[0,1,0]
    v_pk_fma_f32 v[80:81], v[80:81], v[50:51], v[192:193] op_sel:[0,0,0] op_sel_hi:[1,0,1]
    v_pk_mul_f32 v[196:197], v[66:67], v[50:51] op_sel:[0,1] op_sel_hi:[1,1]
    v_pk_mul_f32 v[66:67], v[66:67], v[50:51] op_sel:[0,0] op_sel_hi:[1,0]
    v_pk_fma_f32 v[66:67], v[82:83], v[50:51], v[66:67] op_sel:[0,1,0] op_sel_hi:[1,1,1] neg_lo:[0,1,0] neg_hi:[0,1,0]
    v_pk_fma_f32 v[82:83], v[82:83], v[50:51], v[196:197] op_sel:[0,0,0] op_sel_hi:[1,0,1]
    v_pk_mul_f32 v[192:193], v[68:69], v[50:51] op_sel:[0,1] op_sel_hi:[1,1]
    v_pk_mul_f32 v[68:69], v[68:69], v[50:51] op_sel:[0,0] op_sel_hi:[1,0]
    v_pk_fma_f32 v[68:69], v[84:85], v[50:51], v[68:69] op_sel:[0,1,0] op_sel_hi:[1,1,1] neg_lo:[0,1,0] neg_hi:[0,1,0]
    v_pk_fma_f32 v[84:85], v[84:85], v[50:51], v[192:193] op_sel:[0,0,0] op_sel_hi:[1,0,1]
    v_pk_mul_f32 v[196:197], v[70:71], v[50:51] op_sel:[0,1] op_sel_hi:[1,1]
    v_pk_mul_f32 v[70:71], v[70:71], v[50:51] op_sel:[0,0] op_sel_hi:[1,0]
    v_pk_fma_f32 v[70:71], v[86:87], v[50:51], v[70:71] op_sel:[0,1,0] op_sel_hi:[1,1,1] neg_lo:[0,1,0] neg_hi:[0,1,0]
    v_pk_fma_f32 v[86:87], v[86:87], v[50:51], v[196:197] op_sel:[0,0,0] op_sel_hi:[1,0,1]
    v_pk_mul_f32 v[192:193], v[72:73], v[50:51] op_sel:[0,1] op_sel_hi:[1,1]
    v_pk_mul_f32 v[72:73], v[72:73], v[50:51] op_sel:[0,0] op_sel_hi:[1,0]
    v_pk_fma_f32 v[72:73], v[88:89], v[50:51], v[72:73] op_sel:[0,1,0] op_sel_hi:[1,1,1] neg_lo:[0,1,0] neg_hi:[0,1,0]
    v_pk_fma_f32 v[88:89], v[88:89], v[50:51], v[192:193] op_sel:[0,0,0] op_sel_hi:[1,0,1]
    v_pk_mul_f32 v[196:197], v[74:75], v[50:51] op_sel:[0,1] op_sel_hi:[1,1]
    v_pk_mul_f32 v[74:75], v[74:75], v[50:51] op_sel:[0,0] op_sel_hi:[1,0]
    v_pk_fma_f32 v[74:75], v[90:91], v[50:51], v[74:75] op_sel:[0,1,0] op_sel_hi:[1,1,1] neg_lo:[0,1,0] neg_hi:[0,1,0]
    v_pk_fma_f32 v[90:91], v[90:91], v[50:51], v[196:197] op_sel:[0,0,0] op_sel_hi:[1,0,1]
    v_pk_mul_f32 v[192:193], v[76:77], v[50:51] op_sel:[0,1] op_sel_hi:[1,1]
    v_pk_mul_f32 v[76:77], v[76:77], v[50:51] op_sel:[0,0] op_sel_hi:[1,0]
    v_pk_fma_f32 v[76:77], v[92:93], v[50:51], v[76:77] op_sel:[0,1,0] op_sel_hi:[1,1,1] neg_lo:[0,1,0] neg_hi:[0,1,0]
    v_pk_fma_f32 v[92:93], v[92:93], v[50:51], v[192:193] op_sel:[0,0,0] op_sel_hi:[1,0,1]
    v_pk_mul_f32 v[196:197], v[78:79], v[50:51] op_sel:[0,1] op_sel_hi:[1,1]
    v_pk_mul_f32 v[78:79], v[78:79], v[50:51] op_sel:[0,0] op_sel_hi:[1,0]
    v_pk_fma_f32 v[78:79], v[94:95], v[50:51], v[78:79] op_sel:[0,1,0] op_sel_hi:[1,1,1] neg_lo:[0,1,0] neg_hi:[0,1,0]
    v_pk_fma_f32 v[94:95], v[94:95], v[50:51], v[196:197] op_sel:[0,0,0] op_sel_hi:[1,0,1]
    v_pk_fma_f32 v[196:197], v[64:65], v[38:39], v[66:67] op_sel:[0,0,0] op_sel_hi:[1,0,1]
    v_pk_fma_f32 v[198:199], v[80:81], v[38:39], v[82:83] op_sel:[0,0,0] op_sel_hi:[1,0,1]
    v_pk_fma_f32 v[196:197], v[80:81], v[38:39], v[196:197] op_sel:[0,1,0] op_sel_hi:[1,1,1] neg_lo:[0,1,0] neg_hi:[0,1,0]
    v_pk_fma_f32 v[198:199], v[64:65], v[38:39], v[198:199] op_sel:[0,1,0] op_sel_hi:[1,1,1]
    v_pk_fma_f32 v[192:193], v[196:197], v[38:39], v[68:69] op_sel:[0,0,0] op_sel_hi:[1,0,1]
    v_pk_fma_f32 v[194:195], v[198:199], v[38:39], v[84:85] op_sel:[0,0,0] op_sel_hi:[1,0,1]
    v_pk_fma_f32 v[192:193], v[198:199], v[38:39], v[192:193] op_sel:[0,1,0] op_sel_hi:[1,1,1] neg_lo:[0,1,0] neg_hi:[0,1,0]
    v_pk_fma_f32 v[194:195], v[196:197], v[38:39], v[194:195] op_sel:[0,1,0] op_sel_hi:[1,1,1]
    v_pk_fma_f32 v[196:197], v[192:193], v[38:39], v[70:71] op_sel:[0,0,0] op_sel_hi:[1,0,1]
    v_pk_fma_f32 v[198:199], v[194:195], v[38:39], v[86:87] op_sel:[0,0,0] op_sel_hi:[1,0,1]
    v_pk_fma_f32 v[196:197], v[194:195], v[38:39], v[196:197] op_sel:[0,1,0] op_sel_hi:[1,1,1] neg_lo:[0,1,0] neg_hi:[0,1,0]
    v_pk_fma_f32 v[198:199], v[192:193], v[38:39], v[198:199] op_sel:[0,1,0] op_sel_hi:[1,1,1]
    v_pk_fma_f32 v[192:193], v[196:197], v[38:39], v[72:73] op_sel:[0,0,0] op_sel_hi:[1,0,1]
    v_pk_fma_f32 v[194:195], v[198:199], v[38:39], v[88:89] op_sel:[0,0,0] op_sel_hi:[1,0,1]
    v_pk_fma_f32 v[192:193], v[198:199], v[38:39], v[192:193] op_sel:[0,1,0] op_sel_hi:[1,1,1] neg_lo:[0,1,0] neg_hi:[0,1,0]
    v_pk_fma_f32 v[194:195], v[196:197], v[38:39], v[194:195] op_sel:[0,1,0] op_sel_hi:[1,1,1]
    v_pk_fma_f32 v[196:197], v[192:193], v[38:39], v[74:75] op_sel:[0,0,0] op_sel_hi:[1,0,1]
    v_pk_fma_f32 v[198:199], v[194:195], v[38:39], v[90:91] op_sel:[0,0,0] op_sel_hi:[1,0,1]
    v_pk_fma_f32 v[196:197], v[194:195], v[38:39], v[196:197] op_sel:[0,1,0] op_sel_hi:[1,1,1] neg_lo:[0,1,0] neg_hi:[0,1,0]
    v_pk_fma_f32 v[198:199], v[192:193], v[38:39], v[198:199] op_sel:[0,1,0] op_sel_hi:[1,1,1]
    v_pk_fma_f32 v[192:193], v[196:197], v[38:39], v[76:77] op_sel:[0,0,0] op_sel_hi:[1,0,1]
    v_pk_fma_f32 v[194:195], v[198:199], v[38:39], v[92:93] op_sel:[0,0,0] op_sel_hi:[1,0,1]
    v_pk_fma_f32 v[192:193], v[198:199], v[38:39], v[192:193] op_sel:[0,1,0] op_sel_hi:[1,1,1] neg_lo:[0,1,0] neg_hi:[0,1,0]
    buffer_load_dwordx4 v11, s[44:47], s83 offen offset:2048 lds
    v_pk_fma_f32 v[194:195], v[196:197], v[38:39], v[194:195] op_sel:[0,1,0] op_sel_hi:[1,1,1]
    v_pk_fma_f32 v[196:197], v[192:193], v[38:39], v[78:79] op_sel:[0,0,0] op_sel_hi:[1,0,1]
    v_pk_fma_f32 v[198:199], v[194:195], v[38:39], v[94:95] op_sel:[0,0,0] op_sel_hi:[1,0,1]
    v_pk_fma_f32 v[196:197], v[194:195], v[38:39], v[196:197] op_sel:[0,1,0] op_sel_hi:[1,1,1] neg_lo:[0,1,0] neg_hi:[0,1,0]
    v_pk_fma_f32 v[198:199], v[192:193], v[38:39], v[198:199] op_sel:[0,1,0] op_sel_hi:[1,1,1]
    v_fma_f32 v202, v40, v196, v197
    v_fma_f32 v203, v40, v198, v199
    v_fma_f32 v202, -v41, v198, v202
    v_fma_f32 v203, v41, v196, v203
    v_mov_b32 v200, v196
    v_mov_b32 v204, v202
    v_mov_b32_e64 v205, v203
    v_mov_b32 v201, v198
    v_permlane32_swap_b32 v202, v204
    v_permlane32_swap_b32 v203, v205
    v_fma_f32 v206, v42, v202, v204
    v_fma_f32 v207, v42, v203, v205
    v_fma_f32 v206, -v43, v203, v206
    v_fma_f32 v207, v43, v202, v207
    ds_write_b64 v34, v[206:207]
    s_waitcnt lgkmcnt(0)
    s_waitcnt vmcnt(4)
    s_barrier
    s_add_u32 m0, s34, 64512
    ds_read_b64_tr_b16 v[144:145], v24 offset:0
    buffer_load_dwordx4 v11, s[44:47], s84 offen offset:1024 lds
    buffer_load_dwordx4 v11, s[44:47], s84 offen offset:2048 lds
    ds_read_b64_tr_b16 v[146:147], v24 offset:256
    ds_read_b64_tr_b16 v[148:149], v24 offset:1024
    ds_read_b64_tr_b16 v[150:151], v24 offset:1280
    ds_read_b64_tr_b16 v[152:153], v24 offset:4096
    ds_read_b64_tr_b16 v[154:155], v24 offset:4352
    ds_read_b64_tr_b16 v[156:157], v24 offset:5120
    ds_read_b64_tr_b16 v[158:159], v24 offset:5376
    ds_read_b64_tr_b16 v[160:161], v24 offset:8192
    ds_read_b64_tr_b16 v[162:163], v24 offset:8448
    s_add_u32 m0, s34, 66560
    ds_read_b64_tr_b16 v[164:165], v24 offset:9216
    buffer_load_dwordx4 v11, s[44:47], s85 offen offset:1024 lds
    ds_read_b64_tr_b16 v[166:167], v24 offset:9472
    s_waitcnt lgkmcnt(10)
    v_mfma_f32_32x32x16_bf16 v[96:111], v[144:147], a[128:131], 0
    ds_read_b64 v[208:209], v0 offset:0
    ds_read_b64 v[210:211], v0 offset:256
    ds_read_b64_tr_b16 v[168:169], v24 offset:12288
    ds_read_b64_tr_b16 v[170:171], v24 offset:12544
    s_waitcnt lgkmcnt(11)
    v_mfma_f32_32x32x16_bf16 v[112:127], a[128:131], v[148:151], 0
    ds_read_b64 v[212:213], v0 offset:512
    ds_read_b64 v[214:215], v0 offset:768
    ds_read_b64_tr_b16 v[172:173], v24 offset:13312
    ds_read_b64_tr_b16 v[174:175], v24 offset:13568
    buffer_load_dwordx4 v11, s[44:47], s85 offen offset:2048 lds
    s_waitcnt lgkmcnt(10)
    v_mfma_f32_32x32x16_bf16 v[96:111], v[152:155], a[132:135], v[96:111]
    v_mov_b32 v4, v188
    v_mov_b32_e64 v5, v189
    ds_read_b64_tr_b16 v[144:145], v24 offset:2048
    ds_read_b64_tr_b16 v[146:147], v24 offset:2304
    v_mfma_f32_32x32x16_bf16 v[112:127], a[132:135], v[156:159], v[112:127]
    v_mov_b32 v6, v190
    v_mov_b32_e64 v7, v191
    ds_read_b64_tr_b16 v[148:149], v24 offset:3072
    ds_read_b64_tr_b16 v[150:151], v24 offset:3328
    v_mfma_f32_32x32x16_bf16 v[96:111], v[160:163], a[136:139], v[96:111]
    v_lshl_or_b32 v62, v2, 12, v10
    v_and_b32 v62, 0x10ff, v62
    ds_read_b64_tr_b16 v[152:153], v24 offset:6144
    ds_read_b64_tr_b16 v[154:155], v24 offset:6400
    s_waitcnt lgkmcnt(6)
    v_mfma_f32_32x32x16_bf16 v[112:127], a[136:139], v[164:167], v[112:127]
    v_fma_f32 v216, v44, v208, v210
    s_add_u32 m0, s34, 80896
    v_fma_f32 v217, v44, v209, v211
    buffer_load_dwordx4 v11, s[44:47], s86 offen offset:1024 lds
    ds_read_b64_tr_b16 v[156:157], v24 offset:7168
    ds_read_b64_tr_b16 v[158:159], v24 offset:7424
    v_mfma_f32_32x32x16_bf16 v[96:111], v[168:171], a[140:143], v[96:111]
    v_fma_f32 v216, -v45, v209, v216
    v_fma_f32 v217, v45, v208, v217
    ds_read_b64_tr_b16 v[160:161], v24 offset:10240
    ds_read_b64_tr_b16 v[162:163], v24 offset:10496
    v_mfma_f32_32x32x16_bf16 v[112:127], a[140:143], v[172:175], v[112:127]
    v_fma_f32 v218, v44, v216, v212
    v_fma_f32 v219, v44, v217, v213
    ds_read_b64_tr_b16 v[164:165], v24 offset:11264
    ds_read_b64_tr_b16 v[166:167], v24 offset:11520
    s_waitcnt lgkmcnt(6)
    v_mfma_f32_32x32x16_bf16 v[96:111], v[144:147], a[144:147], v[96:111]
    v_fma_f32 v218, -v45, v217, v218
    v_fma_f32 v219, v45, v216, v219
    ds_read_b64_tr_b16 v[168:169], v24 offset:14336
    buffer_load_dwordx4 v11, s[44:47], s86 offen offset:2048 lds
    ds_read_b64_tr_b16 v[170:171], v24 offset:14592
    v_mfma_f32_32x32x16_bf16 v[112:127], a[144:147], v[148:151], v[112:127]
    v_fma_f32 v220, v44, v218, v214
    v_fma_f32 v221, v44, v219, v215
    ds_read_b64_tr_b16 v[172:173], v24 offset:15360
    ds_read_b64_tr_b16 v[174:175], v24 offset:15616
    v_mfma_f32_32x32x16_bf16 v[96:111], v[152:155], a[148:151], v[96:111]
    v_fma_f32 v220, -v45, v219, v220
    v_fma_f32 v221, v45, v218, v221
    s_waitcnt vmcnt(6)
    s_barrier
    ds_read_b64_tr_b16 v[144:145], v24 offset:16384
    ds_read_b64_tr_b16 v[146:147], v24 offset:16640
    s_waitcnt lgkmcnt(6)
    v_mfma_f32_32x32x16_bf16 v[112:127], a[148:151], v[156:159], v[112:127]
    v_cndmask_b32 v220, v220, 0, s[12:13]
    v_cndmask_b32 v221, v221, 0, s[12:13]
    s_add_u32 m0, s34, 82944
    ds_read_b64_tr_b16 v[148:149], v24 offset:17408
    buffer_load_dwordx4 v11, s[44:47], s87 offen offset:1024 lds
    ds_read_b64_tr_b16 v[150:151], v24 offset:17664
    v_mfma_f32_32x32x16_bf16 v[96:111], v[160:163], a[152:155], v[96:111]
    v_bfi_b32 v220, s97, v60, v220
    buffer_store_dwordx2 v[220:221], v62, s[64:67], s36 offen sc1
    ds_read_b64_tr_b16 v[152:153], v24 offset:20480
    ds_read_b64_tr_b16 v[154:155], v24 offset:20736
    v_mfma_f32_32x32x16_bf16 v[112:127], a[152:155], v[164:167], v[112:127]
    v_cndmask_b32 v222, 0, v208, s[4:5]
    v_cndmask_b32 v223, 0, v209, s[4:5]
    ds_read_b64_tr_b16 v[156:157], v24 offset:21504
    ds_read_b64_tr_b16 v[158:159], v24 offset:21760
    s_waitcnt lgkmcnt(6)
    v_mfma_f32_32x32x16_bf16 v[96:111], v[168:171], a[156:159], v[96:111]
    v_cndmask_b32 v222, v222, v216, s[6:7]
    v_cndmask_b32 v223, v223, v217, s[6:7]
    ds_read_b64_tr_b16 v[160:161], v24 offset:24576
    ds_read_b64_tr_b16 v[162:163], v24 offset:24832
    v_mfma_f32_32x32x16_bf16 v[112:127], a[156:159], v[172:175], v[112:127]
    v_cndmask_b32 v222, v222, v218, s[10:11]
    v_cndmask_b32 v223, v223, v219, s[10:11]
    ds_read_b64_tr_b16 v[164:165], v24 offset:25600
    ds_read_b64_tr_b16 v[166:167], v24 offset:25856
    v_mfma_f32_32x32x16_bf16 v[96:111], v[144:147], a[160:163], v[96:111]
    v_fma_f32 v224, v42, v222, v202
    v_fma_f32 v225, v42, v223, v203
    ds_read_b64_tr_b16 v[168:169], v24 offset:28672
    ds_read_b64_tr_b16 v[170:171], v24 offset:28928
    s_waitcnt lgkmcnt(7)
    v_mfma_f32_32x32x16_bf16 v[112:127], a[160:163], v[148:151], v[112:127]
    v_fma_f32 v224, -v43, v223, v224
    v_fma_f32 v225, v43, v222, v225
    ds_read_b64_tr_b16 v[172:173], v24 offset:29696
    ds_read_b64_tr_b16 v[174:175], v24 offset:29952
    v_mfma_f32_32x32x16_bf16 v[96:111], v[152:155], a[164:167], v[96:111]
    v_cndmask_b32 v12, v222, v224, s[12:13]
    buffer_load_dwordx4 v11, s[44:47], s87 offen offset:2048 lds
    v_cndmask_b32 v14, v223, v225, s[12:13]
    ds_read_b64_tr_b16 v[144:145], v24 offset:18432
    ds_read_b64_tr_b16 v[146:147], v24 offset:18688
    s_waitcnt lgkmcnt(6)
    v_mfma_f32_32x32x16_bf16 v[112:127], a[164:167], v[156:159], v[112:127]
    s_add_u32 m0, s34, 0
    v_fma_f32 v13, v40, v12, v200
    buffer_load_dwordx4 v11, s[44:47], s80 offen lds
    v_fma_f32 v15, v40, v14, v201
    ds_read_b64_tr_b16 v[148:149], v24 offset:19456
    ds_read_b64_tr_b16 v[150:151], v24 offset:19712
    v_mfma_f32_32x32x16_bf16 v[96:111], v[160:163], a[168:171], v[96:111]
    v_fma_f32 v13, -v41, v14, v13
    v_fma_f32 v15, v41, v12, v15
    ds_read_b64_tr_b16 v[152:153], v24 offset:22528
    ds_read_b64_tr_b16 v[154:155], v24 offset:22784
    v_mfma_f32_32x32x16_bf16 v[112:127], a[168:171], v[164:167], v[112:127]
    v_permlane32_swap_b32 v128, v130
    v_add_f32_e64 v128, v128, v130
    s_add_u32 m0, s34, 1024
    ds_read_b64_tr_b16 v[156:157], v24 offset:23552
    buffer_load_dwordx4 v11, s[44:47], s81 offen lds
    ds_read_b64_tr_b16 v[158:159], v24 offset:23808
    s_waitcnt lgkmcnt(6)
    v_mfma_f32_32x32x16_bf16 v[96:111], v[168:171], a[172:175], v[96:111]
    v_mov_b32_e64 v130, v128
    s_lshr_b32 s98, s27, 8
    ds_read_b64_tr_b16 v[160:161], v24 offset:26624
    ds_read_b64_tr_b16 v[162:163], v24 offset:26880
    v_mfma_f32_32x32x16_bf16 v[112:127], a[172:175], v[172:175], v[112:127]
    v_permlane16_swap_b32 v128, v130
    v_add_f32_e64 v128, v128, v130
    ds_read_b64_tr_b16 v[164:165], v24 offset:27648
    ds_read_b64_tr_b16 v[166:167], v24 offset:27904
    v_mfma_f32_32x32x16_bf16 v[96:111], v[144:147], a[176:179], v[96:111]
    v_add_f32_dpp v128, v128, v128 row_ror:8 row_mask:0xf bank_mask:0xf
    s_nop 1
    v_add_f32_dpp v128, v128, v128 row_ror:4 row_mask:0xf bank_mask:0xf
    ds_read_b64_tr_b16 v[168:169], v24 offset:30720
    s_add_u32 m0, s34, 2048
    ds_read_b64_tr_b16 v[170:171], v24 offset:30976
    buffer_load_dwordx4 v11, s[44:47], s82 offen lds
    s_waitcnt lgkmcnt(6)
    v_mfma_f32_32x32x16_bf16 v[112:127], a[176:179], v[148:151], v[112:127]
    v_add_f32_dpp v128, v128, v128 row_ror:2 row_mask:0xf bank_mask:0xf
    s_nop 1
    v_add_f32_dpp v128, v128, v128 row_ror:1 row_mask:0xf bank_mask:0xf
    ds_read_b64_tr_b16 v[172:173], v24 offset:31744
    ds_read_b64_tr_b16 v[174:175], v24 offset:32000
    v_mfma_f32_32x32x16_bf16 v[96:111], v[152:155], a[180:183], v[96:111]
    v_cvt_pk_bf16_f32 v128, v128, v128
    v_and_b32 v128, s32, v128
    s_waitcnt vmcnt(8)
    s_barrier
    ds_read_b64_tr_b16 v[144:145], v24 offset:32768
    ds_read_b64_tr_b16 v[146:147], v24 offset:33024
    v_mfma_f32_32x32x16_bf16 v[112:127], a[180:183], v[156:159], v[112:127]
    v_mul_f32 v128, 0xbfb8aa3b, v128
    s_add_u32 m0, s34, 3072
    v_exp_f32_e64 v128, v128
    buffer_load_dwordx4 v11, s[44:47], s83 offen lds
    ds_read_b64_tr_b16 v[148:149], v24 offset:33792
    ds_read_b64_tr_b16 v[150:151], v24 offset:34048
    s_waitcnt lgkmcnt(6)
    v_mfma_f32_32x32x16_bf16 v[96:111], v[160:163], a[184:187], v[96:111]
    v_lshlrev_b32 v130, 2, v2
    v_add_f32_e64 v128, 1.0, v128
    ds_read_b64_tr_b16 v[152:153], v24 offset:36864
    ds_read_b64_tr_b16 v[154:155], v24 offset:37120
    v_mfma_f32_32x32x16_bf16 v[112:127], a[184:187], v[164:167], v[112:127]
    v_rcp_f32_e64 v128, v128
    s_add_u32 s98, s98, 4096
    ds_read_b64_tr_b16 v[156:157], v24 offset:37888
    ds_read_b64_tr_b16 v[158:159], v24 offset:38144
    v_mfma_f32_32x32x16_bf16 v[96:111], v[168:171], a[188:191], v[96:111]
    v_cvt_pk_bf16_f32 v128, v128, v128
    v_bfi_b32 v128, s33, v60, v128
    s_add_u32 m0, s34, 16384
    ds_read_b64_tr_b16 v[160:161], v24 offset:40960
    buffer_load_dwordx4 v11, s[44:47], s84 offen lds
    ds_read_b64_tr_b16 v[162:163], v24 offset:41216
    s_waitcnt lgkmcnt(6)
    v_mfma_f32_32x32x16_bf16 v[112:127], a[188:191], v[172:175], v[112:127]
    s_mov_b32 exec_lo, 1
    s_mov_b32 exec_hi, 1
    buffer_store_dword v128, v130, s[64:67], s98 offen sc1
    s_mov_b64 exec, -1
    ds_read_b64_tr_b16 v[164:165], v24 offset:41984
    ds_read_b64_tr_b16 v[166:167], v24 offset:42240
    v_mfma_f32_32x32x16_bf16 v[96:111], v[144:147], a[192:195], v[96:111]
    s_lshl_b32 s98, s90, 13
    s_add_u32 s98, s98, 32768
    ds_read_b64_tr_b16 v[168:169], v24 offset:45056
    ds_read_b64_tr_b16 v[170:171], v24 offset:45312
    v_mfma_f32_32x32x16_bf16 v[112:127], a[192:195], v[148:151], v[112:127]
    v_mul_u32_u24 v3, 80, v1
    v_add_u32 v8, s98, v3
    ds_read_b64_tr_b16 v[172:173], v24 offset:46080
    ds_read_b64_tr_b16 v[174:175], v24 offset:46336
    s_waitcnt lgkmcnt(6)
    v_mfma_f32_32x32x16_bf16 v[96:111], v[152:155], a[196:199], v[96:111]
    s_add_u32 s3, s98, 5120
    v_add_u32 v9, s3, v61
    ds_read_b64_tr_b16 v[144:145], v24 offset:34816
    ds_read_b64_tr_b16 v[146:147], v24 offset:35072
    v_mfma_f32_32x32x16_bf16 v[112:127], a[196:199], v[156:159], v[112:127]
    s_add_u32 s98, s98, 32768
    v_and_b32 v3, 31, v1
    ds_read_b64_tr_b16 v[148:149], v24 offset:35840
    ds_read_b64_tr_b16 v[150:151], v24 offset:36096
    v_mfma_f32_32x32x16_bf16 v[96:111], v[160:163], a[200:203], v[96:111]
    v_mul_u32_u24 v3, 80, v3
    v_lshl_add_u32 v3, v2, 5, v3
    ds_read_b64_tr_b16 v[152:153], v24 offset:38912
    ds_read_b64_tr_b16 v[154:155], v24 offset:39168
    s_waitcnt lgkmcnt(7)
    v_mfma_f32_32x32x16_bf16 v[112:127], a[200:203], v[164:167], v[112:127]
    v_add_u32_e64 v22, s98, v3
    v_bfe_u32 v3, v1, 2, 2
    ds_read_b64_tr_b16 v[156:157], v24 offset:39936
    ds_read_b64_tr_b16 v[158:159], v24 offset:40192
    v_mfma_f32_32x32x16_bf16 v[96:111], v[168:171], a[204:207], v[96:111]
    v_lshl_or_b32 v3, v2, 3, v3
    v_mul_u32_u24 v3, 80, v3
    ds_read_b64_tr_b16 v[160:161], v24 offset:43008
    ds_read_b64_tr_b16 v[162:163], v24 offset:43264
    s_waitcnt lgkmcnt(7)
    v_mfma_f32_32x32x16_bf16 v[112:127], a[204:207], v[172:175], v[112:127]
    v_and_b32 v62, 63, v25
    v_add3_u32 v23, s98, v3, v62
    ds_read_b64_tr_b16 v[164:165], v24 offset:44032
    ds_read_b64_tr_b16 v[166:167], v24 offset:44288
    v_mfma_f32_32x32x16_bf16 v[96:111], v[144:147], a[208:211], v[96:111]
    v_bfe_u32 v3, v1, 2, 3
    v_lshl_or_b32 v3, v2, 4, v3
    ds_read_b64_tr_b16 v[168:169], v24 offset:47104
    ds_read_b64_tr_b16 v[170:171], v24 offset:47360
    s_waitcnt lgkmcnt(7)
    v_mfma_f32_32x32x16_bf16 v[112:127], a[208:211], v[148:151], v[112:127]
    v_mul_u32_u24 v3, 80, v3
    v_and_b32 v62, 3, v1
    ds_read_b64_tr_b16 v[172:173], v24 offset:48128
    ds_read_b64_tr_b16 v[174:175], v24 offset:48384
    v_mfma_f32_32x32x16_bf16 v[96:111], v[152:155], a[212:215], v[96:111]
    v_lshl_add_u32 v3, v62, 3, v3
    s_and_b32 s95, s90, 1
    s_waitcnt vmcnt(6)
    s_barrier
    ds_read_b64_tr_b16 v[144:145], v24 offset:49152
    ds_read_b64_tr_b16 v[146:147], v24 offset:49408
    s_waitcnt lgkmcnt(6)
    v_mfma_f32_32x32x16_bf16 v[112:127], a[212:215], v[156:159], v[112:127]
    s_lshr_b32 s96, s90, 1
    s_mul_i32 s98, s95, 2560
    ds_read_b64_tr_b16 v[148:149], v24 offset:50176
    ds_read_b64_tr_b16 v[150:151], v24 offset:50432
    v_mfma_f32_32x32x16_bf16 v[96:111], v[160:163], a[216:219], v[96:111]
    s_lshl_b32 s3, s96, 5
    s_add_u32 s98, s98, s3
    ds_read_b64_tr_b16 v[152:153], v24 offset:53248
    ds_read_b64_tr_b16 v[154:155], v24 offset:53504
    v_mfma_f32_32x32x16_bf16 v[112:127], a[216:219], v[164:167], v[112:127]
    s_add_u32 s98, s98, 32768
    s_add_u32 m0, s34, 17408
    v_add_u32_e64 v20, s98, v3
    buffer_load_dwordx4 v11, s[44:47], s85 offen lds
    ds_read_b64_tr_b16 v[156:157], v24 offset:54272
    ds_read_b64_tr_b16 v[158:159], v24 offset:54528
    s_add_u32 m0, s34, 18432
    s_waitcnt lgkmcnt(6)
    v_mfma_f32_32x32x16_bf16 v[96:111], v[168:171], a[220:223], v[96:111]
    buffer_load_dwordx4 v11, s[44:47], s86 offen lds
    v_and_b32_e64 v3, 15, v1
    v_bfe_u32 v62, v1, 4, 1
    ds_read_b64_tr_b16 v[160:161], v24 offset:57344
    ds_read_b64_tr_b16 v[162:163], v24 offset:57600
    v_mfma_f32_32x32x16_bf16 v[112:127], a[220:223], v[172:175], v[112:127]
    v_lshl_or_b32 v3, v62, 5, v3
    v_lshlrev_b32 v3, 4, v3
    ds_read_b64_tr_b16 v[164:165], v24 offset:58368
    ds_read_b64_tr_b16 v[166:167], v24 offset:58624
    v_mfma_f32_32x32x16_bf16 v[96:111], v[144:147], a[224:227], v[96:111]
    v_lshl_or_b32 v3, v2, 10, v3
    s_lshl_b32 s98, s95, 8
    s_add_u32 m0, s34, 19456
    ds_read_b64_tr_b16 v[168:169], v24 offset:61440
    buffer_load_dwordx4 v11, s[44:47], s87 offen lds
    ds_read_b64_tr_b16 v[170:171], v24 offset:61696
    s_waitcnt lgkmcnt(6)
    v_mfma_f32_32x32x16_bf16 v[112:127], a[224:227], v[148:151], v[112:127]
    s_add_u32 s98, s98, 37888
    v_add_u32 v21, s98, v3
    ds_read_b64_tr_b16 v[172:173], v24 offset:62464
    ds_read_b64_tr_b16 v[174:175], v24 offset:62720
    v_mfma_f32_32x32x16_bf16 v[96:111], v[152:155], a[228:231], v[96:111]
    s_and_b32 s98, s88, 3
    s_lshl_b32 s98, s98, 12
    ds_read_b64_tr_b16 v[144:145], v24 offset:51200
    ds_read_b64_tr_b16 v[146:147], v24 offset:51456
    v_mfma_f32_32x32x16_bf16 v[112:127], a[228:231], v[156:159], v[112:127]
    s_add_u32 s72, s37, s98
    s_xor_b32 s73, s72, 4096
    ds_read_b64_tr_b16 v[148:149], v24 offset:52224
    ds_read_b64_tr_b16 v[150:151], v24 offset:52480
    s_add_u32 m0, s35, 4096
    s_waitcnt lgkmcnt(6)
    v_mfma_f32_32x32x16_bf16 v[96:111], v[160:163], a[232:235], v[96:111]
    buffer_load_dwordx4 v26, s[52:55], s18 offen offset:0 lds
    s_xor_b32 s74, s72, 8192
    s_xor_b32 s75, s72, 12288
    ds_read_b64_tr_b16 v[152:153], v24 offset:55296
    ds_read_b64_tr_b16 v[154:155], v24 offset:55552
    v_mfma_f32_32x32x16_bf16 v[112:127], a[232:235], v[164:167], v[112:127]
    ds_read_b64_tr_b16 v[156:157], v24 offset:56320
    ds_read_b64_tr_b16 v[158:159], v24 offset:56576
    v_mfma_f32_32x32x16_bf16 v[96:111], v[168:171], a[236:239], v[96:111]
    ds_read_b64_tr_b16 v[160:161], v24 offset:59392
    ds_read_b64_tr_b16 v[162:163], v24 offset:59648
    s_waitcnt lgkmcnt(8)
    v_mfma_f32_32x32x16_bf16 v[112:127], a[236:239], v[172:175], v[112:127]
    ds_read_b64_tr_b16 v[164:165], v24 offset:60416
    buffer_load_dwordx4 v27, s[52:55], s18 offen offset:1024 lds
    ds_read_b64_tr_b16 v[166:167], v24 offset:60672
    v_mfma_f32_32x32x16_bf16 v[96:111], v[144:147], a[240:243], v[96:111]
    ds_read_b64_tr_b16 v[168:169], v24 offset:63488
    ds_read_b64_tr_b16 v[170:171], v24 offset:63744
    s_waitcnt lgkmcnt(8)
    v_mfma_f32_32x32x16_bf16 v[112:127], a[240:243], v[148:151], v[112:127]
    ds_read_b64_tr_b16 v[172:173], v24 offset:64512
    ds_read_b64_tr_b16 v[174:175], v24 offset:64768
    v_mfma_f32_32x32x16_bf16 v[96:111], v[152:155], a[244:247], v[96:111]
    s_waitcnt lgkmcnt(8)
    v_mfma_f32_32x32x16_bf16 v[112:127], a[244:247], v[156:159], v[112:127]
    s_waitcnt lgkmcnt(6)
    v_mfma_f32_32x32x16_bf16 v[96:111], v[160:163], a[248:251], v[96:111]
    buffer_load_dwordx4 v28, s[52:55], s18 offen offset:2048 lds
    s_waitcnt lgkmcnt(4)
    v_mfma_f32_32x32x16_bf16 v[112:127], a[248:251], v[164:167], v[112:127]
    buffer_load_dwordx4 v29, s[52:55], s18 offen offset:3072 lds
    s_waitcnt lgkmcnt(2)
    v_mfma_f32_32x32x16_bf16 v[96:111], v[168:171], a[252:255], v[96:111]
    s_waitcnt lgkmcnt(0)
    v_mfma_f32_32x32x16_bf16 v[112:127], a[252:255], v[172:175], v[112:127]
    s_nop 9
    v_cvt_pk_bf16_f32 v128, v96, v97
    v_cvt_pk_bf16_f32 v129, v98, v99
    v_cvt_pk_bf16_f32 v130, v100, v101
    v_cvt_pk_bf16_f32 v131, v102, v103
    v_cvt_pk_bf16_f32 v132, v104, v105
    v_cvt_pk_bf16_f32 v133, v106, v107
    v_cvt_pk_bf16_f32 v134, v108, v109
    v_cvt_pk_bf16_f32 v135, v110, v111
    v_mfma_f32_32x32x16_bf16 v[176:191], v[52:55], v[128:131], 0
    s_nop 0
    v_mfma_f32_32x32x16_bf16 v[176:191], v[56:59], v[132:135], v[176:191]
    v_cvt_pk_bf16_f32 v144, v112, v113
    v_cvt_pk_bf16_f32 v145, v114, v115
    v_cvt_pk_bf16_f32 v146, v116, v117
    v_cvt_pk_bf16_f32 v147, v118, v119
    v_cvt_pk_bf16_f32 v148, v120, v121
    v_cvt_pk_bf16_f32 v149, v122, v123
    v_cvt_pk_bf16_f32 v150, v124, v125
    v_cvt_pk_bf16_f32 v151, v126, v127
    ds_write_b128 v9, v[144:147]
    ds_write_b128 v9, v[148:151] offset:1024
    s_nop 1
    v_cvt_pk_bf16_f32 v128, v176, v177
    v_cvt_pk_bf16_f32 v129, v178, v179
    v_cvt_pk_bf16_f32 v130, v180, v181
    v_cvt_pk_bf16_f32 v131, v182, v183
    v_cvt_pk_bf16_f32 v132, v184, v185
    v_cvt_pk_bf16_f32 v133, v186, v187
    v_cvt_pk_bf16_f32 v134, v188, v189
    v_cvt_pk_bf16_f32 v135, v190, v191
    v_lshlrev_b32 v96, 16, v128
    v_and_b32 v97, s32, v128
    v_lshlrev_b32 v98, 16, v129
    v_and_b32 v99, s32, v129
    v_lshlrev_b32 v100, 16, v130
    v_and_b32 v101, s32, v130
    v_lshlrev_b32 v102, 16, v131
    v_and_b32 v103, s32, v131
    v_lshlrev_b32 v104, 16, v132
    v_and_b32 v105, s32, v132
    v_lshlrev_b32 v106, 16, v133
    v_and_b32 v107, s32, v133
    v_lshlrev_b32 v108, 16, v134
    v_and_b32 v109, s32, v134
    v_lshlrev_b32 v110, 16, v135
    v_and_b32 v111, s32, v135
    v_max3_f32 v168, v96, v97, v98
    v_min3_f32 v169, v96, v97, v98
    v_max3_f32 v168, v168, v99, v100
    v_min3_f32 v169, v169, v99, v100
    v_max3_f32 v168, v168, v101, v102
    v_min3_f32 v169, v169, v101, v102
    v_max3_f32 v168, v168, v103, v104
    v_min3_f32 v169, v169, v103, v104
    v_max3_f32 v168, v168, v105, v106
    v_min3_f32 v169, v169, v105, v106
    v_max3_f32 v168, v168, v107, v108
    v_min3_f32 v169, v169, v107, v108
    v_max3_f32 v168, v168, v109, v110
    v_min3_f32 v169, v169, v109, v110
    v_max_f32 v168, v168, v111
    v_min_f32 v169, v169, v111
    v_pk_mul_f32 v[168:169], v[168:169], s[38:39] neg_lo:[1,0]
    v_pk_fma_f32 v[176:177], v[96:97], s[38:39], v[168:169] op_sel:[0,0,0] op_sel_hi:[1,1,0]
    v_pk_fma_f32 v[128:129], v[96:97], s[38:39], v[168:169] op_sel:[0,0,1] op_sel_hi:[1,1,1] neg_lo:[1,0,0] neg_hi:[1,0,0]
    v_pk_fma_f32 v[178:179], v[98:99], s[38:39], v[168:169] op_sel:[0,0,0] op_sel_hi:[1,1,0]
    v_pk_fma_f32 v[130:131], v[98:99], s[38:39], v[168:169] op_sel:[0,0,1] op_sel_hi:[1,1,1] neg_lo:[1,0,0] neg_hi:[1,0,0]
    v_pk_fma_f32 v[180:181], v[100:101], s[38:39], v[168:169] op_sel:[0,0,0] op_sel_hi:[1,1,0]
    v_pk_fma_f32 v[132:133], v[100:101], s[38:39], v[168:169] op_sel:[0,0,1] op_sel_hi:[1,1,1] neg_lo:[1,0,0] neg_hi:[1,0,0]
    v_pk_fma_f32 v[182:183], v[102:103], s[38:39], v[168:169] op_sel:[0,0,0] op_sel_hi:[1,1,0]
    v_pk_fma_f32 v[134:135], v[102:103], s[38:39], v[168:169] op_sel:[0,0,1] op_sel_hi:[1,1,1] neg_lo:[1,0,0] neg_hi:[1,0,0]
    v_pk_fma_f32 v[184:185], v[104:105], s[38:39], v[168:169] op_sel:[0,0,0] op_sel_hi:[1,1,0]
    v_pk_fma_f32 v[136:137], v[104:105], s[38:39], v[168:169] op_sel:[0,0,1] op_sel_hi:[1,1,1] neg_lo:[1,0,0] neg_hi:[1,0,0]
    v_pk_fma_f32 v[186:187], v[106:107], s[38:39], v[168:169] op_sel:[0,0,0] op_sel_hi:[1,1,0]
    v_pk_fma_f32 v[138:139], v[106:107], s[38:39], v[168:169] op_sel:[0,0,1] op_sel_hi:[1,1,1] neg_lo:[1,0,0] neg_hi:[1,0,0]
    v_pk_fma_f32 v[188:189], v[108:109], s[38:39], v[168:169] op_sel:[0,0,0] op_sel_hi:[1,1,0]
    v_pk_fma_f32 v[140:141], v[108:109], s[38:39], v[168:169] op_sel:[0,0,1] op_sel_hi:[1,1,1] neg_lo:[1,0,0] neg_hi:[1,0,0]
    v_pk_fma_f32 v[190:191], v[110:111], s[38:39], v[168:169] op_sel:[0,0,0] op_sel_hi:[1,1,0]
    v_pk_fma_f32 v[142:143], v[110:111], s[38:39], v[168:169] op_sel:[0,0,1] op_sel_hi:[1,1,1] neg_lo:[1,0,0] neg_hi:[1,0,0]
    v_exp_f32 v176, v176
    v_exp_f32 v128, v128
    s_add_u32 m0, s35, 8192
    v_exp_f32 v177, v177
    buffer_load_dwordx4 v26, s[52:55], s19 offen offset:0 lds
    v_exp_f32 v129, v129
    v_exp_f32 v178, v178
    buffer_load_dwordx4 v27, s[52:55], s19 offen offset:1024 lds
    v_exp_f32 v130, v130
    v_exp_f32 v179, v179
    v_exp_f32 v131, v131
    v_exp_f32 v180, v180
    v_exp_f32 v132, v132
    v_exp_f32 v181, v181
    v_exp_f32 v133, v133
    v_exp_f32 v182, v182
    v_exp_f32 v134, v134
    v_exp_f32 v183, v183
    v_exp_f32 v135, v135
    buffer_load_dwordx4 v28, s[52:55], s19 offen offset:2048 lds
    v_exp_f32 v184, v184
    v_exp_f32 v136, v136
    v_exp_f32 v185, v185
    v_exp_f32 v137, v137
    buffer_load_dwordx4 v29, s[52:55], s19 offen offset:3072 lds
    v_exp_f32 v186, v186
    v_exp_f32 v138, v138
    v_exp_f32 v187, v187
    v_exp_f32 v139, v139
    v_exp_f32 v188, v188
    v_exp_f32 v140, v140
    v_exp_f32 v189, v189
    v_exp_f32 v141, v141
    v_exp_f32_e64 v190, v190
    v_exp_f32_e64 v142, v142
    v_exp_f32_e64 v191, v191
    buffer_load_dwordx2 v[224:225], v10, s[64:67], s36 offen offset:256 sc1
    v_exp_f32_e64 v143, v143
    v_pk_add_f32 v[96:97], v[176:177], v[178:179]
    v_pk_add_f32 v[104:105], v[128:129], v[130:131]
    v_pk_add_f32 v[98:99], v[180:181], v[182:183]
    v_pk_add_f32 v[106:107], v[132:133], v[134:135]
    v_pk_add_f32 v[100:101], v[184:185], v[186:187]
    buffer_load_dwordx2 v[226:227], v10, s[64:67], s36 offen offset:768 sc1
    v_pk_add_f32 v[108:109], v[136:137], v[138:139]
    v_pk_add_f32 v[102:103], v[188:189], v[190:191]
    v_pk_add_f32 v[110:111], v[140:141], v[142:143]
    v_pk_add_f32 v[96:97], v[96:97], v[98:99]
    v_pk_add_f32 v[100:101], v[100:101], v[102:103]
    v_pk_add_f32 v[104:105], v[104:105], v[106:107]
    v_pk_add_f32 v[108:109], v[108:109], v[110:111]
    v_pk_add_f32 v[96:97], v[96:97], v[100:101]
    v_pk_add_f32 v[104:105], v[104:105], v[108:109]
    v_add_f32_e64 v168, v96, v97
    v_add_f32_e64 v169, v104, v105
    v_rcp_f32_e64 v168, v168
    v_rcp_f32_e64 v169, v169
    buffer_load_dwordx2 v[228:229], v10, s[64:67], s36 offen offset:1280 sc1
    v_pk_mul_f32 v[176:177], v[176:177], v[168:169] op_sel:[0,0] op_sel_hi:[1,0]
    v_pk_mul_f32 v[178:179], v[178:179], v[168:169] op_sel:[0,0] op_sel_hi:[1,0]
    v_pk_mul_f32 v[180:181], v[180:181], v[168:169] op_sel:[0,0] op_sel_hi:[1,0]
    buffer_load_dwordx2 v[230:231], v10, s[64:67], s36 offen offset:1792 sc1
    v_pk_mul_f32 v[182:183], v[182:183], v[168:169] op_sel:[0,0] op_sel_hi:[1,0]
    v_cvt_pk_bf16_f32 v152, v176, v177
    v_cvt_pk_bf16_f32 v153, v178, v179
    v_cvt_pk_bf16_f32 v154, v180, v181
    v_cvt_pk_bf16_f32 v155, v182, v183
    ds_write_b128 v8, v[152:155] offset:0
    buffer_load_dwordx2 v[232:233], v10, s[64:67], s36 offen offset:2304 sc1
    v_pk_mul_f32 v[184:185], v[184:185], v[168:169] op_sel:[0,0] op_sel_hi:[1,0]
    buffer_load_dwordx2 v[234:235], v10, s[64:67], s36 offen offset:2816 sc1
    v_pk_mul_f32 v[186:187], v[186:187], v[168:169] op_sel:[0,0] op_sel_hi:[1,0]
    v_pk_mul_f32 v[188:189], v[188:189], v[168:169] op_sel:[0,0] op_sel_hi:[1,0]
    v_pk_mul_f32 v[190:191], v[190:191], v[168:169] op_sel:[0,0] op_sel_hi:[1,0]
    v_cvt_pk_bf16_f32 v156, v184, v185
    v_cvt_pk_bf16_f32 v157, v186, v187
    v_cvt_pk_bf16_f32 v158, v188, v189
    v_cvt_pk_bf16_f32 v159, v190, v191
    ds_write_b128 v8, v[156:159] offset:16
    v_pk_mul_f32 v[128:129], v[128:129], v[168:169] op_sel:[0,1] op_sel_hi:[1,1]
    v_pk_mul_f32 v[130:131], v[130:131], v[168:169] op_sel:[0,1] op_sel_hi:[1,1]
    v_pk_mul_f32 v[132:133], v[132:133], v[168:169] op_sel:[0,1] op_sel_hi:[1,1]
    v_pk_mul_f32 v[134:135], v[134:135], v[168:169] op_sel:[0,1] op_sel_hi:[1,1]
    v_cvt_pk_bf16_f32 v160, v128, v129
    v_cvt_pk_bf16_f32 v161, v130, v131
    v_cvt_pk_bf16_f32 v162, v132, v133
    v_cvt_pk_bf16_f32 v163, v134, v135
    ds_write_b128 v8, v[160:163] offset:32
    v_pk_mul_f32 v[136:137], v[136:137], v[168:169] op_sel:[0,1] op_sel_hi:[1,1]
    v_pk_mul_f32 v[138:139], v[138:139], v[168:169] op_sel:[0,1] op_sel_hi:[1,1]
    v_pk_mul_f32 v[140:141], v[140:141], v[168:169] op_sel:[0,1] op_sel_hi:[1,1]
    v_pk_mul_f32 v[142:143], v[142:143], v[168:169] op_sel:[0,1] op_sel_hi:[1,1]
    v_cvt_pk_bf16_f32 v164, v136, v137
    v_cvt_pk_bf16_f32 v165, v138, v139
    v_cvt_pk_bf16_f32 v166, v140, v141
    v_cvt_pk_bf16_f32 v167, v142, v143
    ds_write_b128 v8, v[164:167] offset:48
    v_mov_b32 v172, 0x3f803f80
    v_mov_b32 v173, 0x3f803f80
    v_mov_b32 v174, 0x3f803f80
    v_mov_b32 v175, 0x3f803f80
    buffer_load_dwordx2 v[236:237], v10, s[64:67], s36 offen offset:3328 sc1
    buffer_load_dwordx2 v[238:239], v10, s[64:67], s36 offen offset:3840 sc1
    s_waitcnt vmcnt(0)
    v_bitop3_b32 v224, v224, v60, s97 bitop3:0x78
    ds_read_b128 a[0:3], v16 offset:4096
    ds_read_b128 a[8:11], v17 offset:4096
    ds_read_b128 a[32:35], v18 offset:4096
    ds_read_b128 a[40:43], v19 offset:4096
    v_bitop3_b32 v226, v226, v60, s97 bitop3:0x78
    ds_read_b128 a[4:7], v16 offset:8192
    ds_read_b128 a[12:15], v17 offset:8192
    ds_read_b128 a[36:39], v18 offset:8192
    ds_read_b128 a[44:47], v19 offset:8192
    v_bitop3_b32 v228, v228, v60, s97 bitop3:0x78
    s_add_u32 m0, s35, 12288
    v_bitop3_b32 v230, v230, v60, s97 bitop3:0x78
    buffer_load_dwordx4 v26, s[56:59], s18 offen offset:0 lds
    s_waitcnt lgkmcnt(4)
    buffer_load_dwordx4 v27, s[56:59], s18 offen offset:1024 lds
    v_bitop3_b32 v232, v232, v60, s97 bitop3:0x78
    buffer_load_dwordx4 v28, s[56:59], s18 offen offset:2048 lds
    v_bitop3_b32 v234, v234, v60, s97 bitop3:0x78
    v_bitop3_b32 v236, v236, v60, s97 bitop3:0x78
    v_bitop3_b32 v238, v238, v60, s97 bitop3:0x78
    v_or3_b32 v3, v224, v226, v228
    buffer_load_dwordx4 v29, s[56:59], s18 offen offset:3072 lds
    v_or3_b32 v3, v3, v230, v232
    v_or3_b32 v3, v3, v234, v236
    v_bitop3_b32 v3, v3, v238, s97 bitop3:0xa8
    v_cmp_ne_u32_e64 vcc, 0, v3
    s_cbranch_vccnz L_slow_e
L_back_e:
    s_waitcnt lgkmcnt(0)
    s_barrier
    s_add_u32 m0, s35, 0
    ds_read_b64_tr_b16 v[96:97], v20 offset:0
    buffer_load_dwordx4 v26, s[56:59], s19 offen offset:0 lds
    buffer_load_dwordx4 v27, s[56:59], s19 offen offset:1024 lds
    ds_read_b64_tr_b16 v[98:99], v20 offset:640
    ds_read_b128 v[112:115], v21 offset:0
    buffer_load_dwordx4 v28, s[56:59], s19 offen offset:2048 lds
    ds_read_b64_tr_b16 v[100:101], v20 offset:8192
    ds_read_b64_tr_b16 v[102:103], v20 offset:8832
    ds_read_b128 v[116:119], v21 offset:8192
    buffer_load_dwordx4 v29, s[56:59], s19 offen offset:3072 lds
    ds_read_b64_tr_b16 v[104:105], v20 offset:16384
    ds_read_b64_tr_b16 v[106:107], v20 offset:17024
    s_add_u32 m0, s35, 4096
    ds_read_b128 v[120:123], v21 offset:16384
    buffer_load_dwordx4 v26, s[52:55], s20 offen offset:0 lds
    buffer_load_dwordx4 v27, s[52:55], s20 offen offset:1024 lds
    ds_read_b64_tr_b16 v[108:109], v20 offset:24576
    ds_read_b64_tr_b16 v[110:111], v20 offset:25216
    ds_read_b128 v[124:127], v21 offset:24576
    v_fma_f32 v236, v48, v238, v236
    v_fma_f32 v237, v48, v239, v237
    v_fma_f32 v236, -v49, v239, v236
    v_fma_f32 v237, v49, v238, v237
    v_fma_f32 v234, v48, v236, v234
    v_fma_f32 v235, v48, v237, v235
    v_fma_f32 v234, -v49, v237, v234
    v_fma_f32 v235, v49, v236, v235
    s_waitcnt lgkmcnt(5)
    v_mfma_f32_16x16x32_bf16 v[128:131], v[96:99], v[112:115], 0
    v_fma_f32 v232, v48, v234, v232
    v_fma_f32 v233, v48, v235, v233
    v_mfma_f32_16x16x32_bf16 v[132:135], v[96:99], v[172:175], 0
    v_fma_f32 v232, -v49, v235, v232
    v_fma_f32 v233, v49, v234, v233
    v_mfma_f32_16x16x32_bf16 v[128:131], v[100:103], v[116:119], v[128:131]
    v_fma_f32 v230, v48, v232, v230
    v_fma_f32 v231, v48, v233, v231
    v_mfma_f32_16x16x32_bf16 v[132:135], v[100:103], v[172:175], v[132:135]
    v_fma_f32 v230, -v49, v233, v230
    v_fma_f32 v231, v49, v232, v231
    s_waitcnt lgkmcnt(1)
    v_mfma_f32_16x16x32_bf16 v[128:131], v[104:107], v[120:123], v[128:131]
    v_fma_f32 v228, v48, v230, v228
    v_fma_f32 v229, v48, v231, v229
    v_mfma_f32_16x16x32_bf16 v[132:135], v[104:107], v[172:175], v[132:135]
    v_fma_f32 v228, -v49, v231, v228
    v_fma_f32 v229, v49, v230, v229
    s_waitcnt lgkmcnt(0)
    v_mfma_f32_16x16x32_bf16 v[128:131], v[108:111], v[124:127], v[128:131]
    v_fma_f32 v226, v48, v228, v226
    v_fma_f32 v227, v48, v229, v227
    v_mfma_f32_16x16x32_bf16 v[132:135], v[108:111], v[172:175], v[132:135]
    v_fma_f32 v226, -v49, v229, v226
    v_fma_f32 v227, v49, v228, v227
    v_fma_f32 v224, v48, v226, v224
    v_fma_f32 v225, v48, v227, v225
    v_fma_f32 v224, -v49, v227, v224
    v_fma_f32 v225, v49, v226, v225
    v_mov_b32 v240, v224
    v_mov_b32 v241, v225
    v_and_b32_e64 v3, 0x30, v1
    v_permlane32_swap_b32 v224, v240
    v_permlane32_swap_b32 v225, v241
    v_fma_f32 v224, v46, v240, v224
    v_fma_f32 v225, v46, v241, v225
    v_fma_f32 v224, -v47, v241, v224
    v_fma_f32 v225, v47, v240, v225
    v_bfi_b32 v128, s97, v60, v128
    v_bfi_b32 v132, s97, v60, v132
    buffer_store_dwordx4 v[128:131], v61, s[64:67], s1 offen sc1
    s_mov_b32 exec_lo, 0x10001
    s_mov_b32 exec_hi, 0x10001
    buffer_store_dwordx4 v[132:135], v3, s[64:67], s17 offen sc1
    s_mov_b64 exec, -1
    v_pk_fma_f32 v[12:13], v[4:5], v[224:225], v[12:13] op_sel:[0,0,0] op_sel_hi:[1,0,1]
    v_pk_fma_f32 v[14:15], v[6:7], v[224:225], v[14:15] op_sel:[0,0,0] op_sel_hi:[1,0,1]
    v_pk_fma_f32 v[12:13], v[6:7], v[224:225], v[12:13] op_sel:[0,1,0] op_sel_hi:[1,1,1] neg_lo:[0,1,0] neg_hi:[0,1,0]
    v_pk_fma_f32 v[14:15], v[4:5], v[224:225], v[14:15] op_sel:[0,1,0] op_sel_hi:[1,1,1]
    v_pk_fma_f32 v[64:65], v[12:13], v[38:39], v[64:65] op_sel:[0,0,0] op_sel_hi:[1,0,1]
    v_pk_fma_f32 v[80:81], v[14:15], v[38:39], v[80:81] op_sel:[0,0,0] op_sel_hi:[1,0,1]
    v_pk_fma_f32 v[64:65], v[14:15], v[38:39], v[64:65] op_sel:[0,1,0] op_sel_hi:[1,1,1] neg_lo:[0,1,0] neg_hi:[0,1,0]
    v_pk_fma_f32 v[80:81], v[12:13], v[38:39], v[80:81] op_sel:[0,1,0] op_sel_hi:[1,1,1]
    v_pk_fma_f32 v[66:67], v[64:65], v[38:39], v[66:67] op_sel:[0,0,0] op_sel_hi:[1,0,1]
    v_pk_fma_f32 v[82:83], v[80:81], v[38:39], v[82:83] op_sel:[0,0,0] op_sel_hi:[1,0,1]
    v_pk_fma_f32 v[66:67], v[80:81], v[38:39], v[66:67] op_sel:[0,1,0] op_sel_hi:[1,1,1] neg_lo:[0,1,0] neg_hi:[0,1,0]
    v_pk_fma_f32 v[82:83], v[64:65], v[38:39], v[82:83] op_sel:[0,1,0] op_sel_hi:[1,1,1]
    v_pk_fma_f32 v[68:69], v[66:67], v[38:39], v[68:69] op_sel:[0,0,0] op_sel_hi:[1,0,1]
    v_pk_fma_f32 v[84:85], v[82:83], v[38:39], v[84:85] op_sel:[0,0,0] op_sel_hi:[1,0,1]
    v_pk_fma_f32 v[68:69], v[82:83], v[38:39], v[68:69] op_sel:[0,1,0] op_sel_hi:[1,1,1] neg_lo:[0,1,0] neg_hi:[0,1,0]
    v_pk_fma_f32 v[84:85], v[66:67], v[38:39], v[84:85] op_sel:[0,1,0] op_sel_hi:[1,1,1]
    v_pk_fma_f32 v[70:71], v[68:69], v[38:39], v[70:71] op_sel:[0,0,0] op_sel_hi:[1,0,1]
    v_pk_fma_f32 v[86:87], v[84:85], v[38:39], v[86:87] op_sel:[0,0,0] op_sel_hi:[1,0,1]
    v_pk_fma_f32 v[70:71], v[84:85], v[38:39], v[70:71] op_sel:[0,1,0] op_sel_hi:[1,1,1] neg_lo:[0,1,0] neg_hi:[0,1,0]
    v_pk_fma_f32 v[86:87], v[68:69], v[38:39], v[86:87] op_sel:[0,1,0] op_sel_hi:[1,1,1]
    v_pk_fma_f32 v[72:73], v[70:71], v[38:39], v[72:73] op_sel:[0,0,0] op_sel_hi:[1,0,1]
    v_pk_fma_f32 v[88:89], v[86:87], v[38:39], v[88:89] op_sel:[0,0,0] op_sel_hi:[1,0,1]
    v_pk_fma_f32 v[72:73], v[86:87], v[38:39], v[72:73] op_sel:[0,1,0] op_sel_hi:[1,1,1] neg_lo:[0,1,0] neg_hi:[0,1,0]
    v_pk_fma_f32 v[88:89], v[70:71], v[38:39], v[88:89] op_sel:[0,1,0] op_sel_hi:[1,1,1]
    v_pk_fma_f32 v[74:75], v[72:73], v[38:39], v[74:75] op_sel:[0,0,0] op_sel_hi:[1,0,1]
    v_pk_fma_f32 v[90:91], v[88:89], v[38:39], v[90:91] op_sel:[0,0,0] op_sel_hi:[1,0,1]
    v_pk_fma_f32 v[74:75], v[88:89], v[38:39], v[74:75] op_sel:[0,1,0] op_sel_hi:[1,1,1] neg_lo:[0,1,0] neg_hi:[0,1,0]
    v_pk_fma_f32 v[90:91], v[72:73], v[38:39], v[90:91] op_sel:[0,1,0] op_sel_hi:[1,1,1]
    v_pk_fma_f32 v[76:77], v[74:75], v[38:39], v[76:77] op_sel:[0,0,0] op_sel_hi:[1,0,1]
    v_pk_fma_f32 v[92:93], v[90:91], v[38:39], v[92:93] op_sel:[0,0,0] op_sel_hi:[1,0,1]
    v_pk_fma_f32 v[76:77], v[90:91], v[38:39], v[76:77] op_sel:[0,1,0] op_sel_hi:[1,1,1] neg_lo:[0,1,0] neg_hi:[0,1,0]
    v_pk_fma_f32 v[92:93], v[74:75], v[38:39], v[92:93] op_sel:[0,1,0] op_sel_hi:[1,1,1]
    v_pk_fma_f32 v[78:79], v[76:77], v[38:39], v[78:79] op_sel:[0,0,0] op_sel_hi:[1,0,1]
    v_pk_fma_f32 v[94:95], v[92:93], v[38:39], v[94:95] op_sel:[0,0,0] op_sel_hi:[1,0,1]
    v_pk_fma_f32 v[78:79], v[92:93], v[38:39], v[78:79] op_sel:[0,1,0] op_sel_hi:[1,1,1] neg_lo:[0,1,0] neg_hi:[0,1,0]
    v_pk_fma_f32 v[94:95], v[76:77], v[38:39], v[94:95] op_sel:[0,1,0] op_sel_hi:[1,1,1]
    v_cvt_pk_bf16_f32 v224, v64, v66
    v_cvt_pk_bf16_f32 v225, v68, v70
    v_cvt_pk_bf16_f32 v226, v72, v74
    v_cvt_pk_bf16_f32 v227, v76, v78
    ds_write_b128 v22, v[224:227] offset:0
    v_cvt_pk_bf16_f32 v228, v65, v67
    v_cvt_pk_bf16_f32 v229, v69, v71
    v_cvt_pk_bf16_f32 v230, v73, v75
    v_cvt_pk_bf16_f32 v231, v77, v79
    ds_write_b128 v22, v[228:231] offset:16
    v_cvt_pk_bf16_f32 v232, -v80, -v82
    v_cvt_pk_bf16_f32 v233, -v84, -v86
    v_cvt_pk_bf16_f32 v234, -v88, -v90
    v_cvt_pk_bf16_f32 v235, -v92, -v94
    ds_write_b128 v22, v[232:235] offset:2560
    v_cvt_pk_bf16_f32 v236, -v81, -v83
    v_cvt_pk_bf16_f32 v237, -v85, -v87
    v_cvt_pk_bf16_f32 v238, -v89, -v91
    v_cvt_pk_bf16_f32 v239, -v93, -v95
    ds_write_b128 v22, v[236:239] offset:2576
    ds_read_b64_tr_b16 v[240:241], v23 offset:0
    ds_read_b64_tr_b16 v[242:243], v23 offset:320
    ds_read_b64_tr_b16 v[244:245], v23 offset:1280
    ds_read_b64_tr_b16 v[246:247], v23 offset:1600
    ds_read_b64_tr_b16 v[248:249], v23 offset:2560
    ds_read_b64_tr_b16 v[250:251], v23 offset:2880
    ds_read_b64_tr_b16 v[252:253], v23 offset:3840
    ds_read_b64_tr_b16 v[254:255], v23 offset:4160
    v_mov_b32 v164, -1
    v_mov_b32 v165, -1
    v_mov_b32 v166, -1
    v_mov_b32 v167, -1
    ds_read_b64_tr_b16 v[208:209], v25 offset:0
    ds_read_b64_tr_b16 v[210:211], v25 offset:256
    buffer_load_dwordx4 v28, s[52:55], s20 offen offset:2048 lds
    ds_read_b64_tr_b16 v[212:213], v25 offset:4096
    ds_read_b64_tr_b16 v[214:215], v25 offset:4352
    ds_read_b64_tr_b16 v[216:217], v25 offset:8192
    buffer_load_dwordx4 v29, s[52:55], s20 offen offset:3072 lds
    ds_read_b64_tr_b16 v[218:219], v25 offset:8448
    s_add_u32 m0, s35, 8192
    ds_read_b64_tr_b16 v[220:221], v25 offset:12288
    buffer_load_dwordx4 v26, s[52:55], s21 offen offset:0 lds
    ds_read_b64_tr_b16 v[222:223], v25 offset:12544
    ds_read_b64_tr_b16 v[224:225], v25 offset:1024
    ds_read_b64_tr_b16 v[226:227], v25 offset:1280
    buffer_load_dwordx4 v27, s[52:55], s21 offen offset:1024 lds
    s_waitcnt lgkmcnt(8)
    v_mfma_f32_32x32x16_bf16 v[176:191], v[208:211], a[128:131], 0
    s_and_b32 s95, s90, 1
    v_and_b32_e64 v47, 31, v1
    ds_read_b64_tr_b16 v[228:229], v25 offset:5120
    ds_read_b64_tr_b16 v[230:231], v25 offset:5376
    buffer_store_dwordx4 v[240:243], v61, s[64:67], s15 offen offset:0 sc1
    s_waitcnt lgkmcnt(8)
    v_mfma_f32_32x32x16_bf16 v[176:191], v[212:215], a[132:135], v[176:191]
    s_lshl_b32 s98, s93, 7
    s_lshl_b32 s3, s95, 6
    ds_read_b64_tr_b16 v[232:233], v25 offset:9216
    ds_read_b64_tr_b16 v[234:235], v25 offset:9472
    buffer_store_dwordx4 v[244:247], v61, s[64:67], s15 offen offset:1024 sc1
    s_waitcnt lgkmcnt(7)
    v_mfma_f32_32x32x16_bf16 v[176:191], v[216:219], a[136:139], v[176:191]
    s_add_u32 s98, s98, s3
    v_and_b32 v46, 7, v1
    ds_read_b64_tr_b16 v[208:209], v25 offset:13312
    ds_read_b64_tr_b16 v[210:211], v25 offset:13568
    buffer_store_dwordx4 v[248:251], v61, s[64:67], s15 offen offset:2048 sc1
    s_waitcnt lgkmcnt(6)
    v_mfma_f32_32x32x16_bf16 v[176:191], v[220:223], a[140:143], v[176:191]
    v_lshl_add_u32 v46, v46, 3, s98
    s_lshl_b32 s3, s26, 5
    ds_read_b64_tr_b16 v[212:213], v25 offset:2048
    ds_read_b64_tr_b16 v[214:215], v25 offset:2304
    buffer_store_dwordx4 v[252:255], v61, s[64:67], s15 offen offset:3072 sc1
    v_mfma_f32_32x32x16_bf16 v[176:191], v[224:227], a[144:147], v[176:191]
    v_lshrrev_b32_e64 v11, 3, v1
    v_add_u32_e64 v11, s3, v11
    ds_read_b64_tr_b16 v[216:217], v25 offset:6144
    ds_read_b64_tr_b16 v[218:219], v25 offset:6400
    buffer_store_dwordx4 v[164:167], v61, s[64:67], s16 offen offset:0 sc1
    s_waitcnt lgkmcnt(6)
    v_mfma_f32_32x32x16_bf16 v[176:191], v[228:231], a[148:151], v[176:191]
    v_lshl_add_u32 v11, v11, 10, v46
    s_mov_b32 s78, 8192
    ds_read_b64_tr_b16 v[220:221], v25 offset:10240
    ds_read_b64_tr_b16 v[222:223], v25 offset:10496
    buffer_store_dwordx4 v[164:167], v61, s[64:67], s16 offen offset:1024 sc1
    v_mfma_f32_32x32x16_bf16 v[176:191], v[232:235], a[152:155], v[176:191]
    s_mov_b32 s79, 16384
    s_mov_b32 s80, 24576
    ds_read_b64_tr_b16 v[224:225], v25 offset:14336
    ds_read_b64_tr_b16 v[226:227], v25 offset:14592
    s_waitcnt lgkmcnt(6)
    v_mfma_f32_32x32x16_bf16 v[176:191], v[208:211], a[156:159], v[176:191]
    buffer_load_dwordx4 v28, s[52:55], s21 offen offset:2048 lds
    s_lshl_b32 s98, s26, 7
    s_waitcnt vmcnt(19)
    ds_read_b128 a[16:19], v16 offset:12288
    ds_read_b128 a[24:27], v17 offset:12288
    ds_read_b128 a[48:51], v18 offset:12288
    ds_read_b128 a[56:59], v19 offset:12288
    s_add_u32 s98, s98, 4096
    buffer_load_dwordx4 v29, s[52:55], s21 offen offset:3072 lds
    ds_read_b64_tr_b16 v[228:229], v25 offset:3072
    ds_read_b64_tr_b16 v[230:231], v25 offset:3328
    v_mfma_f32_32x32x16_bf16 v[176:191], v[212:215], a[160:163], v[176:191]
    v_lshl_add_u32 v38, v47, 2, s98
    v_xor_b32 v39, 128, v38
    ds_read_b64_tr_b16 v[232:233], v25 offset:7168
    ds_read_b64_tr_b16 v[234:235], v25 offset:7424
    s_waitcnt lgkmcnt(7)
    v_mfma_f32_32x32x16_bf16 v[176:191], v[216:219], a[164:167], v[176:191]
    s_lshr_b32 s96, s90, 1
    s_mul_i32 s98, s95, 1280
    ds_read_b64_tr_b16 v[208:209], v25 offset:11264
    ds_read_b64_tr_b16 v[210:211], v25 offset:11520
    s_waitcnt lgkmcnt(6)
    s_add_u32 m0, s35, 12288
    v_mfma_f32_32x32x16_bf16 v[176:191], v[220:223], a[168:171], v[176:191]
    buffer_load_dwordx4 v26, s[56:59], s20 offen offset:0 lds
    buffer_load_dwordx4 v27, s[56:59], s20 offen offset:1024 lds
    s_lshl_b32 s3, s96, 5
    buffer_load_dwordx4 v28, s[56:59], s20 offen offset:2048 lds
    s_add_u32 s98, s98, s3
    ds_read_b64_tr_b16 v[212:213], v25 offset:15360
    ds_read_b64_tr_b16 v[214:215], v25 offset:15616
    buffer_load_dwordx4 v29, s[56:59], s20 offen offset:3072 lds
    v_mfma_f32_32x32x16_bf16 v[176:191], v[224:227], a[172:175], v[176:191]
    s_add_u32 s98, s98, 70656
    v_and_b32_e64 v20, 15, v1
    ds_read_b64_tr_b16 v[216:217], v25 offset:16384
    s_waitcnt vmcnt(20)
    ds_read_b128 a[20:23], v16 offset:0
    ds_read_b128 a[28:31], v17 offset:0
    ds_read_b128 a[52:55], v18 offset:0
    ds_read_b128 a[60:63], v19 offset:0
    ds_read_b64_tr_b16 v[218:219], v25 offset:16640
    s_waitcnt lgkmcnt(6)
    v_mfma_f32_32x32x16_bf16 v[176:191], v[228:231], a[176:179], v[176:191]
    v_mul_u32_u24 v8, 80, v20
    v_lshrrev_b32 v62, 4, v1
    ds_read_b64_tr_b16 v[220:221], v25 offset:20480
    ds_read_b64_tr_b16 v[222:223], v25 offset:20736
    v_mfma_f32_32x32x16_bf16 v[176:191], v[232:235], a[180:183], v[176:191]
    v_lshl_add_u32 v8, v62, 3, v8
    v_add_u32_e64 v8, s98, v8
    ds_read_b64_tr_b16 v[224:225], v25 offset:24576
    ds_read_b64_tr_b16 v[226:227], v25 offset:24832
    v_mfma_f32_32x32x16_bf16 v[176:191], v[208:211], a[184:187], v[176:191]
    s_mul_i32 s98, s95, 80
    s_add_u32 s98, s98, s3
    s_waitcnt lgkmcnt(5)
    ds_read_b64_tr_b16 v[228:229], v25 offset:28672
    ds_read_b64_tr_b16 v[230:231], v25 offset:28928
    v_mfma_f32_32x32x16_bf16 v[176:191], v[212:215], a[188:191], v[176:191]
    s_add_u32 s98, s98, 73216
    v_and_b32_e64 v21, 3, v1
    ds_read_b64_tr_b16 v[232:233], v25 offset:17408
    ds_read_b64_tr_b16 v[234:235], v25 offset:17664
    s_waitcnt lgkmcnt(7)
    v_mfma_f32_32x32x16_bf16 v[176:191], v[216:219], a[192:195], v[176:191]
    v_lshlrev_b32_e64 v9, 3, v21
    v_bfe_u32 v62, v1, 4, 1
    ds_read_b64_tr_b16 v[208:209], v25 offset:21504
    ds_read_b64_tr_b16 v[210:211], v25 offset:21760
    s_waitcnt lgkmcnt(7)
    v_mfma_f32_32x32x16_bf16 v[176:191], v[220:223], a[196:199], v[176:191]
    v_lshl_or_b32 v9, v62, 2, v9
    v_lshl_or_b32 v9, v2, 1, v9
    ds_read_b64_tr_b16 v[212:213], v25 offset:25600
    ds_read_b64_tr_b16 v[214:215], v25 offset:25856
    s_waitcnt lgkmcnt(7)
    v_mfma_f32_32x32x16_bf16 v[176:191], v[224:227], a[200:203], v[176:191]
    v_add_u32 v9, s98, v9
    v_lshlrev_b32_e64 v20, 2, v20
    ds_read_b64_tr_b16 v[216:217], v25 offset:29696
    ds_read_b64_tr_b16 v[218:219], v25 offset:29952
    s_waitcnt lgkmcnt(7)
    v_mfma_f32_32x32x16_bf16 v[176:191], v[228:231], a[204:207], v[176:191]
    s_add_u32 m0, s35, 0
    v_add_u32 v20, 73376, v20
    buffer_load_dwordx4 v26, s[56:59], s21 offen offset:0 lds
    v_bfe_u32 v34, v1, 3, 2
    ds_read_b64_tr_b16 v[220:221], v25 offset:18432
    ds_read_b64_tr_b16 v[222:223], v25 offset:18688
    s_waitcnt lgkmcnt(6)
    v_mfma_f32_32x32x16_bf16 v[176:191], v[232:235], a[208:211], v[176:191]
    v_lshl_add_u32 v21, v34, 2, v21
    v_lshl_add_u32 v21, v2, 4, v21
    ds_read_b64_tr_b16 v[224:225], v25 offset:22528
    buffer_load_dwordx4 v27, s[56:59], s21 offen offset:1024 lds
    ds_read_b64_tr_b16 v[226:227], v25 offset:22784
    v_mfma_f32_32x32x16_bf16 v[176:191], v[208:211], a[212:215], v[176:191]
    v_mul_u32_u24 v21, 80, v21
    v_add_u32 v21, 70656, v21
    ds_read_b64_tr_b16 v[228:229], v25 offset:26624
    ds_read_b64_tr_b16 v[230:231], v25 offset:26880
    s_waitcnt lgkmcnt(6)
    v_mfma_f32_32x32x16_bf16 v[176:191], v[212:215], a[216:219], v[176:191]
    v_mul_u32_u24 v0, 80, v2
    buffer_load_dwordx4 v28, s[56:59], s21 offen offset:2048 lds
    v_add_u32 v0, 73216, v0
    ds_read_b64_tr_b16 v[232:233], v25 offset:30720
    ds_read_b64_tr_b16 v[234:235], v25 offset:30976
    s_waitcnt vmcnt(9)
    s_mov_b64 exec, 1
    v_mov_b32 v3, 147456
    buffer_store_dword v60, v3, s[64:67], s8 offen sc1
    s_mov_b64 exec, -1
    v_mfma_f32_32x32x16_bf16 v[176:191], v[216:219], a[220:223], v[176:191]
    v_mov_b32 v62, 73376
    s_mov_b32 s76, 0xf0f0f0f0
    ds_read_b64_tr_b16 v[208:209], v25 offset:19456
    ds_read_b64_tr_b16 v[210:211], v25 offset:19712
    ds_read_b128 a[64:67], v16 offset:4096
    ds_read_b128 a[72:75], v17 offset:4096
    ds_read_b128 a[96:99], v18 offset:4096
    ds_read_b128 a[104:107], v19 offset:4096
    s_waitcnt lgkmcnt(6)
    v_mfma_f32_32x32x16_bf16 v[176:191], v[220:223], a[224:227], v[176:191]
    buffer_load_dwordx4 v29, s[56:59], s21 offen offset:3072 lds
    s_mov_b32 s77, 0x0f0f0f0f
    v_cndmask_b32 v21, v21, v62, s[76:77]
    ds_read_b64_tr_b16 v[212:213], v25 offset:23552
    ds_read_b64_tr_b16 v[214:215], v25 offset:23808
    v_mfma_f32_32x32x16_bf16 v[176:191], v[224:227], a[228:231], v[176:191]
    v_cndmask_b32 v0, v0, v62, s[76:77]
    v_bfe_u32 v62, v1, 1, 1
    ds_read_b64_tr_b16 v[216:217], v25 offset:27648
    ds_read_b64_tr_b16 v[218:219], v25 offset:27904
    v_mfma_f32_32x32x16_bf16 v[176:191], v[228:231], a[232:235], v[176:191]
    v_lshl_or_b32 v34, v34, 1, v62
    v_and_b32 v62, 1, v1
    ds_read_b64_tr_b16 v[220:221], v25 offset:31744
    s_waitcnt lgkmcnt(5)
    s_add_u32 m0, s35, 4096
    ds_read_b64_tr_b16 v[222:223], v25 offset:32000
    buffer_load_dwordx4 v30, s[60:63], s22 offen offset:0 lds
    buffer_load_dwordx4 v31, s[60:63], s22 offen offset:1024 lds
    v_mfma_f32_32x32x16_bf16 v[176:191], v[232:235], a[236:239], v[176:191]
    buffer_load_dwordx4 v32, s[60:63], s22 offen offset:2048 lds
    v_lshl_or_b32 v34, v62, 3, v34
    v_bfe_u32 v62, v1, 2, 1
    v_mfma_f32_32x32x16_bf16 v[176:191], v[208:211], a[240:243], v[176:191]
    buffer_load_dwordx4 v33, s[60:63], s22 offen offset:3072 lds
    v_lshl_or_b32 v34, v62, 4, v34
    v_lshl_or_b32 v34, v2, 5, v34
    s_waitcnt lgkmcnt(4)
    v_mfma_f32_32x32x16_bf16 v[176:191], v[212:215], a[244:247], v[176:191]
    v_lshlrev_b32_e64 v34, 4, v34
    s_lshr_b32 s98, s26, 3
    s_waitcnt lgkmcnt(2)
    v_mfma_f32_32x32x16_bf16 v[176:191], v[216:219], a[248:251], v[176:191]
    s_lshl_b32 s98, s98, 19
    s_and_b32 s3, s26, 7
    s_waitcnt lgkmcnt(0)
    v_mfma_f32_32x32x16_bf16 v[176:191], v[220:223], a[252:255], v[176:191]
    s_lshl_b32 s3, s3, 12
    s_add_u32 s98, s98, s3
    s_add_u32 s98, s98, 2097152
    v_add_u32_e64 v4, s98, v61
    v_xor_b32 v5, 4096, v4
    s_lshr_b32 s98, s26, 4
    s_lshl_b32 s98, s98, 19
    s_and_b32 s3, s26, 15
    s_lshl_b32 s3, s3, 11
    s_add_u32 s98, s98, s3
    s_waitcnt vmcnt(13)
    ds_read_b128 a[68:71], v16 offset:8192
    ds_read_b128 a[76:79], v17 offset:8192
    ds_read_b128 a[100:103], v18 offset:8192
    ds_read_b128 a[108:111], v19 offset:8192
    s_add_u32 s98, s98, 6291456
    v_add_u32 v6, s98, v61
    v_xor_b32 v7, 2048, v6
    v_cvt_pk_bf16_f32 v80, v176, v177
    v_cvt_pk_bf16_f32 v81, v178, v179
    v_cvt_pk_bf16_f32 v82, v180, v181
    v_cvt_pk_bf16_f32 v83, v182, v183
    v_cvt_pk_bf16_f32 v84, v184, v185
    v_cvt_pk_bf16_f32 v85, v186, v187
    v_cvt_pk_bf16_f32 v86, v188, v189
    v_cvt_pk_bf16_f32 v87, v190, v191
    v_mfma_f32_32x32x16_bf16 v[64:79], v[52:55], v[80:83], 0
    s_nop 0
    v_mfma_f32_32x32x16_bf16 v[64:79], v[56:59], v[84:87], v[64:79]
    s_nop 11
    v_cvt_pk_bf16_f32 v80, v64, v65
    v_cvt_pk_bf16_f32 v81, v66, v67
    v_cvt_pk_bf16_f32 v82, v68, v69
    s_waitcnt lgkmcnt(0)
    s_add_u32 m0, s35, 8192
    v_cvt_pk_bf16_f32 v83, v70, v71
    buffer_load_dwordx4 v30, s[60:63], s23 offen offset:0 lds
    buffer_load_dwordx4 v31, s[60:63], s23 offen offset:1024 lds
    v_cvt_pk_bf16_f32 v84, v72, v73
    buffer_load_dwordx4 v32, s[60:63], s23 offen offset:2048 lds
    v_cvt_pk_bf16_f32 v85, v74, v75
    v_cvt_pk_bf16_f32 v86, v76, v77
    v_cvt_pk_bf16_f32 v87, v78, v79
    v_lshlrev_b32 v176, 16, v80
    buffer_load_dwordx4 v33, s[60:63], s23 offen offset:3072 lds
    v_and_b32 v177, s32, v80
    v_lshlrev_b32 v178, 16, v81
    v_and_b32 v179, s32, v81
    v_lshlrev_b32 v180, 16, v82
    v_and_b32 v181, s32, v82
    v_lshlrev_b32 v182, 16, v83
    v_and_b32 v183, s32, v83
    buffer_load_dword v40, v38, s[64:67], 0 offen sc1
    v_lshlrev_b32 v184, 16, v84
    v_and_b32_e64 v185, s32, v84
    s_waitcnt vmcnt(14)
    ds_read_b128 a[80:83], v16 offset:12288
    ds_read_b128 a[88:91], v17 offset:12288
    ds_read_b128 a[112:115], v18 offset:12288
    ds_read_b128 a[120:123], v19 offset:12288
    v_lshlrev_b32 v186, 16, v85
    v_and_b32 v187, s32, v85
    v_lshlrev_b32 v188, 16, v86
    v_and_b32 v189, s32, v86
    v_lshlrev_b32 v190, 16, v87
    v_and_b32 v191, s32, v87
    v_max3_f32 v164, v176, v177, v178
    v_min3_f32 v165, v176, v177, v178
    v_max3_f32 v164, v164, v179, v180
    v_min3_f32 v165, v165, v179, v180
    v_max3_f32 v164, v164, v181, v182
    v_min3_f32 v165, v165, v181, v182
    v_max3_f32 v164, v164, v183, v184
    v_min3_f32 v165, v165, v183, v184
    v_max3_f32 v164, v164, v185, v186
    v_min3_f32 v165, v165, v185, v186
    v_max3_f32 v164, v164, v187, v188
    v_min3_f32 v165, v165, v187, v188
    v_max3_f32 v164, v164, v189, v190
    v_min3_f32 v165, v165, v189, v190
    v_max_f32 v164, v164, v191
    v_min_f32_e64 v165, v165, v191
    v_pk_mul_f32 v[164:165], v[164:165], s[38:39] neg_lo:[1,0]
    v_pk_fma_f32 v[64:65], v[176:177], s[38:39], v[164:165] op_sel:[0,0,0] op_sel_hi:[1,1,0]
    s_waitcnt lgkmcnt(0)
    v_pk_fma_f32 v[80:81], v[176:177], s[38:39], v[164:165] op_sel:[0,0,1] op_sel_hi:[1,1,1] neg_lo:[1,0,0] neg_hi:[1,0,0]
    v_pk_fma_f32 v[66:67], v[178:179], s[38:39], v[164:165] op_sel:[0,0,0] op_sel_hi:[1,1,0]
    v_pk_fma_f32 v[82:83], v[178:179], s[38:39], v[164:165] op_sel:[0,0,1] op_sel_hi:[1,1,1] neg_lo:[1,0,0] neg_hi:[1,0,0]
    v_pk_fma_f32 v[68:69], v[180:181], s[38:39], v[164:165] op_sel:[0,0,0] op_sel_hi:[1,1,0]
    v_pk_fma_f32 v[84:85], v[180:181], s[38:39], v[164:165] op_sel:[0,0,1] op_sel_hi:[1,1,1] neg_lo:[1,0,0] neg_hi:[1,0,0]
    v_pk_fma_f32 v[70:71], v[182:183], s[38:39], v[164:165] op_sel:[0,0,0] op_sel_hi:[1,1,0]
    v_pk_fma_f32 v[86:87], v[182:183], s[38:39], v[164:165] op_sel:[0,0,1] op_sel_hi:[1,1,1] neg_lo:[1,0,0] neg_hi:[1,0,0]
    v_pk_fma_f32 v[72:73], v[184:185], s[38:39], v[164:165] op_sel:[0,0,0] op_sel_hi:[1,1,0]
    v_pk_fma_f32 v[88:89], v[184:185], s[38:39], v[164:165] op_sel:[0,0,1] op_sel_hi:[1,1,1] neg_lo:[1,0,0] neg_hi:[1,0,0]
    v_pk_fma_f32 v[74:75], v[186:187], s[38:39], v[164:165] op_sel:[0,0,0] op_sel_hi:[1,1,0]
    v_pk_fma_f32 v[90:91], v[186:187], s[38:39], v[164:165] op_sel:[0,0,1] op_sel_hi:[1,1,1] neg_lo:[1,0,0] neg_hi:[1,0,0]
    v_pk_fma_f32 v[76:77], v[188:189], s[38:39], v[164:165] op_sel:[0,0,0] op_sel_hi:[1,1,0]
    v_pk_fma_f32 v[92:93], v[188:189], s[38:39], v[164:165] op_sel:[0,0,1] op_sel_hi:[1,1,1] neg_lo:[1,0,0] neg_hi:[1,0,0]
    v_pk_fma_f32 v[78:79], v[190:191], s[38:39], v[164:165] op_sel:[0,0,0] op_sel_hi:[1,1,0]
    v_pk_fma_f32 v[94:95], v[190:191], s[38:39], v[164:165] op_sel:[0,0,1] op_sel_hi:[1,1,1] neg_lo:[1,0,0] neg_hi:[1,0,0]
    v_exp_f32 v64, v64
    v_exp_f32 v80, v80
    v_exp_f32 v65, v65
    v_exp_f32 v81, v81
    v_exp_f32 v66, v66
    v_exp_f32 v82, v82
    v_exp_f32 v67, v67
    v_exp_f32 v83, v83
    v_exp_f32 v68, v68
    v_exp_f32 v84, v84
    v_exp_f32 v69, v69
    v_exp_f32 v85, v85
    v_exp_f32 v70, v70
    v_exp_f32 v86, v86
    v_exp_f32 v71, v71
    v_exp_f32 v87, v87
    v_exp_f32 v72, v72
    v_exp_f32 v88, v88
    buffer_load_dword v41, v39, s[64:67], 0 offen sc1
    v_exp_f32 v73, v73
    v_exp_f32 v89, v89
    v_exp_f32 v74, v74
    v_exp_f32 v90, v90
    v_exp_f32 v75, v75
    v_exp_f32 v91, v91
    v_exp_f32 v76, v76
    v_exp_f32 v92, v92
    v_exp_f32 v77, v77
    v_exp_f32 v93, v93
    v_exp_f32 v78, v78
    v_exp_f32 v94, v94
    v_exp_f32_e64 v79, v79
    v_exp_f32_e64 v95, v95
    v_pk_add_f32 v[176:177], v[64:65], v[66:67]
    v_pk_add_f32 v[184:185], v[80:81], v[82:83]
    v_pk_add_f32 v[178:179], v[68:69], v[70:71]
    v_pk_add_f32 v[186:187], v[84:85], v[86:87]
    v_pk_add_f32 v[180:181], v[72:73], v[74:75]
    v_pk_add_f32 v[188:189], v[88:89], v[90:91]
    v_pk_add_f32 v[182:183], v[76:77], v[78:79]
    v_pk_add_f32 v[190:191], v[92:93], v[94:95]
    v_pk_add_f32 v[176:177], v[176:177], v[178:179]
    v_pk_add_f32 v[180:181], v[180:181], v[182:183]
    v_pk_add_f32 v[184:185], v[184:185], v[186:187]
    v_pk_add_f32 v[188:189], v[188:189], v[190:191]
    v_pk_add_f32 v[176:177], v[176:177], v[180:181]
    v_pk_add_f32 v[184:185], v[184:185], v[188:189]
    v_add_f32_e64 v164, v176, v177
    v_add_f32_e64 v165, v184, v185
    v_rcp_f32 v164, v164
    buffer_load_dwordx4 v[160:163], v61, s[64:67], s9 offen sc1
    v_rcp_f32_e64 v165, v165
    buffer_load_dwordx4 v[96:99], v61, s[64:67], s72 offen offset:0 sc1
    v_pk_mul_f32 v[64:65], v[64:65], v[164:165] op_sel:[0,0] op_sel_hi:[1,0]
    v_pk_mul_f32 v[80:81], v[80:81], v[164:165] op_sel:[0,1] op_sel_hi:[1,1]
    v_pk_mul_f32 v[66:67], v[66:67], v[164:165] op_sel:[0,0] op_sel_hi:[1,0]
    v_pk_mul_f32 v[82:83], v[82:83], v[164:165] op_sel:[0,1] op_sel_hi:[1,1]
    v_pk_mul_f32 v[68:69], v[68:69], v[164:165] op_sel:[0,0] op_sel_hi:[1,0]
    v_pk_mul_f32 v[84:85], v[84:85], v[164:165] op_sel:[0,1] op_sel_hi:[1,1]
    v_pk_mul_f32 v[70:71], v[70:71], v[164:165] op_sel:[0,0] op_sel_hi:[1,0]
    v_pk_mul_f32 v[86:87], v[86:87], v[164:165] op_sel:[0,1] op_sel_hi:[1,1]
    v_pk_mul_f32 v[72:73], v[72:73], v[164:165] op_sel:[0,0] op_sel_hi:[1,0]
    v_pk_mul_f32 v[88:89], v[88:89], v[164:165] op_sel:[0,1] op_sel_hi:[1,1]
    v_pk_mul_f32 v[74:75], v[74:75], v[164:165] op_sel:[0,0] op_sel_hi:[1,0]
    buffer_load_dwordx4 v[100:103], v61, s[64:67], s72 offen offset:1024 sc1
    v_pk_mul_f32 v[90:91], v[90:91], v[164:165] op_sel:[0,1] op_sel_hi:[1,1]
    v_pk_mul_f32 v[76:77], v[76:77], v[164:165] op_sel:[0,0] op_sel_hi:[1,0]
    v_pk_mul_f32 v[92:93], v[92:93], v[164:165] op_sel:[0,1] op_sel_hi:[1,1]
    v_pk_mul_f32 v[78:79], v[78:79], v[164:165] op_sel:[0,0] op_sel_hi:[1,0]
    v_pk_mul_f32 v[94:95], v[94:95], v[164:165] op_sel:[0,1] op_sel_hi:[1,1]
    v_cvt_pk_bf16_f32 v224, v64, v65
    v_cvt_pk_bf16_f32 v225, v66, v67
    v_cvt_pk_bf16_f32 v226, v68, v69
    v_cvt_pk_bf16_f32 v227, v70, v71
    v_cvt_pk_bf16_f32 v228, v72, v73
    v_cvt_pk_bf16_f32 v229, v74, v75
    v_cvt_pk_bf16_f32 v230, v76, v77
    s_waitcnt vmcnt(13)
    ds_read_b128 a[84:87], v16 offset:0
    ds_read_b128 a[92:95], v17 offset:0
    ds_read_b128 a[116:119], v18 offset:0
    ds_read_b128 a[124:127], v19 offset:0
    v_cvt_pk_bf16_f32 v231, v78, v79
    buffer_load_dwordx4 v[104:107], v61, s[64:67], s72 offen offset:2048 sc1
    v_cvt_pk_bf16_f32 v232, v80, v81
    buffer_load_dwordx4 v[108:111], v61, s[64:67], s72 offen offset:3072 sc1
    v_cvt_pk_bf16_f32 v233, v82, v83
    v_cvt_pk_bf16_f32 v234, v84, v85
    v_cvt_pk_bf16_f32 v235, v86, v87
    v_cvt_pk_bf16_f32 v236, v88, v89
    v_cvt_pk_bf16_f32 v237, v90, v91
    v_cvt_pk_bf16_f32 v238, v92, v93
    v_cvt_pk_bf16_f32 v239, v94, v95
    buffer_load_dwordx4 v[112:115], v61, s[64:67], s73 offen offset:0 sc1
    buffer_load_dwordx4 v[116:119], v61, s[64:67], s73 offen offset:1024 sc1
    buffer_load_dwordx4 v[120:123], v61, s[64:67], s73 offen offset:2048 sc1
    buffer_load_dwordx4 v[124:127], v61, s[64:67], s73 offen offset:3072 sc1
    buffer_load_dwordx4 v[128:131], v61, s[64:67], s74 offen offset:0 sc1
    buffer_load_dwordx4 v[132:135], v61, s[64:67], s74 offen offset:1024 sc1
    buffer_load_dwordx4 v[136:139], v61, s[64:67], s74 offen offset:2048 sc1
    buffer_load_dwordx4 v[140:143], v61, s[64:67], s74 offen offset:3072 sc1
    buffer_load_dwordx4 v[144:147], v61, s[64:67], s75 offen offset:0 sc1
    buffer_load_dwordx4 v[148:151], v61, s[64:67], s75 offen offset:1024 sc1
    buffer_load_dwordx4 v[152:155], v61, s[64:67], s75 offen offset:2048 sc1
    buffer_load_dwordx4 v[156:159], v61, s[64:67], s75 offen offset:3072 sc1
    buffer_load_dword v22, v35, s[64:67], s14 offen sc1
    s_waitcnt vmcnt(17)
    v_bitop3_b32 v160, v160, v60, s97 bitop3:0x78
    s_waitcnt lgkmcnt(0)
    s_waitcnt vmcnt(16)
    v_bitop3_b32 v96, v96, v60, s97 bitop3:0x78
    s_waitcnt vmcnt(15)
    v_bitop3_b32 v100, v100, v60, s97 bitop3:0x78
    v_or3_b32 v3, v160, v96, v100
    v_pk_add_f32 v[96:97], v[96:97], v[100:101]
    v_pk_add_f32 v[98:99], v[98:99], v[102:103]
    s_waitcnt vmcnt(14)
    v_bitop3_b32 v104, v104, v60, s97 bitop3:0x78
    s_waitcnt vmcnt(13)
    v_bitop3_b32 v108, v108, v60, s97 bitop3:0x78
    v_or3_b32 v3, v3, v104, v108
    v_pk_add_f32 v[104:105], v[104:105], v[108:109]
    v_pk_add_f32 v[106:107], v[106:107], v[110:111]
    v_pk_add_f32 v[96:97], v[96:97], v[104:105]
    v_pk_add_f32 v[98:99], v[98:99], v[106:107]
    s_waitcnt vmcnt(12)
    v_bitop3_b32 v112, v112, v60, s97 bitop3:0x78
    s_waitcnt vmcnt(11)
    v_bitop3_b32 v116, v116, v60, s97 bitop3:0x78
    v_or3_b32 v3, v3, v112, v116
    v_pk_add_f32 v[112:113], v[112:113], v[116:117]
    v_pk_add_f32 v[114:115], v[114:115], v[118:119]
    v_pk_add_f32 v[96:97], v[96:97], v[112:113]
    v_pk_add_f32 v[98:99], v[98:99], v[114:115]
    s_waitcnt vmcnt(10)
    v_bitop3_b32 v120, v120, v60, s97 bitop3:0x78
    s_waitcnt vmcnt(9)
    v_bitop3_b32 v124, v124, v60, s97 bitop3:0x78
    s_add_u32 m0, s35, 12288
    v_or3_b32 v3, v3, v120, v124
    buffer_load_dwordx4 v30, s[60:63], s24 offen offset:0 lds
    v_pk_add_f32 v[120:121], v[120:121], v[124:125]
    v_pk_add_f32 v[122:123], v[122:123], v[126:127]
    v_pk_add_f32 v[96:97], v[96:97], v[120:121]
    v_pk_add_f32 v[98:99], v[98:99], v[122:123]
    s_waitcnt vmcnt(9)
    v_bitop3_b32 v128, v128, v60, s97 bitop3:0x78
    buffer_load_dwordx4 v31, s[60:63], s24 offen offset:1024 lds
    s_waitcnt vmcnt(9)
    v_bitop3_b32 v132, v132, v60, s97 bitop3:0x78
    buffer_load_dwordx4 v32, s[60:63], s24 offen offset:2048 lds
    v_or3_b32 v3, v3, v128, v132
    v_pk_add_f32 v[128:129], v[128:129], v[132:133]
    v_pk_add_f32 v[130:131], v[130:131], v[134:135]
    v_pk_add_f32 v[96:97], v[96:97], v[128:129]
    v_pk_add_f32 v[98:99], v[98:99], v[130:131]
    s_waitcnt vmcnt(9)
    v_bitop3_b32 v136, v136, v60, s97 bitop3:0x78
    buffer_load_dwordx4 v33, s[60:63], s24 offen offset:3072 lds
    s_waitcnt vmcnt(9)
    v_bitop3_b32 v140, v140, v60, s97 bitop3:0x78
    s_add_u32 m0, s35, 0
    v_or3_b32 v3, v3, v136, v140
    buffer_load_dwordx4 v30, s[60:63], s25 offen offset:0 lds
    v_pk_add_f32 v[136:137], v[136:137], v[140:141]
    v_pk_add_f32 v[138:139], v[138:139], v[142:143]
    v_pk_add_f32 v[96:97], v[96:97], v[136:137]
    v_pk_add_f32 v[98:99], v[98:99], v[138:139]
    s_waitcnt vmcnt(9)
    v_bitop3_b32 v144, v144, v60, s97 bitop3:0x78
    buffer_load_dwordx4 v31, s[60:63], s25 offen offset:1024 lds
    s_waitcnt vmcnt(9)
    v_bitop3_b32 v148, v148, v60, s97 bitop3:0x78
    buffer_load_dwordx4 v32, s[60:63], s25 offen offset:2048 lds
    v_or3_b32 v3, v3, v144, v148
    v_pk_add_f32 v[144:145], v[144:145], v[148:149]
    v_pk_add_f32 v[146:147], v[146:147], v[150:151]
    v_pk_add_f32 v[96:97], v[96:97], v[144:145]
    v_pk_add_f32 v[98:99], v[98:99], v[146:147]
    s_waitcnt vmcnt(9)
    v_bitop3_b32 v152, v152, v60, s97 bitop3:0x78
    buffer_load_dwordx4 v33, s[60:63], s25 offen offset:3072 lds
    s_waitcnt vmcnt(9)
    v_bitop3_b32 v156, v156, v60, s97 bitop3:0x78
    buffer_load_dwordx2 v[26:27], v11, s[40:43], 0 offen
    v_or3_b32 v3, v3, v152, v156
    v_and_b32 v3, s97, v3
    v_cmp_ne_u32_e64 vcc, 0, v3
    v_pk_add_f32 v[152:153], v[152:153], v[156:157]
    v_pk_add_f32 v[154:155], v[154:155], v[158:159]
    v_pk_add_f32 v[96:97], v[96:97], v[152:153]
    v_pk_add_f32 v[98:99], v[98:99], v[154:155]
    s_cbranch_vccnz L_slow_kv
L_back_kv:
    s_waitcnt vmcnt(9)
    v_cmp_ne_u32 vcc, s91, v22
    buffer_load_dwordx2 v[28:29], v11, s[40:43], s78 offen
    s_cbranch_vccnz L_slow_fh
L_back_fh:
    v_permlane32_swap_b32 v160, v161
    v_permlane32_swap_b32 v162, v163
    v_cvt_pk_bf16_f32 v96, v96, v97
    v_cvt_pk_bf16_f32 v97, v98, v99
    v_add_f32 v160, v160, v161
    v_add_f32 v162, v162, v163
    ds_write_b64 v8, v[96:97]
    v_mov_b32 v161, 0
    v_permlane16_swap_b32 v160, v162
    buffer_load_dwordx2 v[30:31], v11, s[40:43], s79 offen
    v_add_f32 v160, v160, v162
    ds_write_b32 v20, v161
    s_nop 0
    v_add_f32_dpp v160, v160, v160 row_ror:8 row_mask:0xf bank_mask:0xf
    s_nop 1
    v_add_f32_dpp v160, v160, v160 row_ror:4 row_mask:0xf bank_mask:0xf
    v_cvt_pk_bf16_f32 v160, v160, v160
    ds_write_b16 v9, v160
    v_xor_b32 v3, v60, v40
    v_bitop3_b32 v3, v41, v60, v3 bitop3:0xbe
    v_and_b32 v3, s33, v3
    v_cmp_ne_u32_e64 vcc, 0, v3
    s_cbranch_vccnz L_slow_g
L_back_g:
    s_waitcnt lgkmcnt(0)
    s_barrier
    buffer_load_dwordx2 v[32:33], v11, s[40:43], s80 offen
    ds_read_b128 v[104:107], v21 offset:0
    ds_read_b128 v[108:111], v21 offset:16
    ds_read_b128 v[112:115], v21 offset:32
    global_load_dwordx2 v[14:15], v46, s[28:29]
    ds_read_b128 v[116:119], v21 offset:48
    ds_read_b128 v[120:123], v0 offset:0
    ds_read_b128 v[124:127], v0 offset:16
    buffer_load_dwordx4 a[128:131], v4, s[64:67], s22 offen offset:0 sc1
    ds_read_b128 v[128:131], v0 offset:32
    ds_read_b128 v[132:135], v0 offset:48
    v_and_b32 v40, s32, v40
    v_sub_f32 v42, 1.0, v40
    v_max_f32 v40, 0x0da24260, v40
    buffer_load_dwordx4 a[132:135], v5, s[64:67], s22 offen offset:0 sc1
    v_cvt_pk_bf16_f32 v42, v42, v42
    v_rcp_f32 v43, v40
    v_and_b32 v42, s32, v42
    v_add_f32 v42, v42, v42
    v_mul_f32_e64 v42, v42, v43
    s_waitcnt lgkmcnt(4)
    v_mfma_f32_32x32x16_bf16 v[136:151], v[104:107], v[224:227], 0
    v_mfma_f32_32x32x16_bf16 v[136:151], v[108:111], v[228:231], v[136:151]
    buffer_load_dwordx4 a[136:139], v4, s[64:67], s22 offen offset:1024 sc1
    v_mfma_f32_32x32x16_bf16 v[136:151], v[112:115], v[232:235], v[136:151]
    v_mfma_f32_32x32x16_bf16 v[136:151], v[116:119], v[236:239], v[136:151]
    buffer_load_dwordx4 a[140:143], v5, s[64:67], s22 offen offset:1024 sc1
    s_waitcnt lgkmcnt(2)
    v_mfma_f32_32x32x16_bf16 v[152:167], v[120:123], v[224:227], 0
    v_and_b32 v41, s32, v41
    v_sub_f32 v44, 1.0, v41
    v_max_f32 v41, 0x0da24260, v41
    v_cvt_pk_bf16_f32 v44, v44, v44
    v_mfma_f32_32x32x16_bf16 v[152:167], v[124:127], v[228:231], v[152:167]
    buffer_load_dwordx4 a[144:147], v4, s[64:67], s22 offen offset:2048 sc1
    v_rcp_f32 v45, v41
    v_and_b32 v44, s32, v44
    v_add_f32 v44, v44, v44
    v_mul_f32 v44, v44, v45
    s_waitcnt lgkmcnt(0)
    v_mfma_f32_32x32x16_bf16 v[152:167], v[128:131], v[232:235], v[152:167]
    v_cvt_pk_bf16_f32 v104, v136, v137
    v_cvt_pk_bf16_f32 v105, v138, v139
    v_cvt_pk_bf16_f32 v106, v140, v141
    v_cvt_pk_bf16_f32 v107, v142, v143
    v_cvt_pk_bf16_f32 v108, v144, v145
    v_mfma_f32_32x32x16_bf16 v[152:167], v[132:135], v[236:239], v[152:167]
    buffer_load_dwordx4 a[148:151], v5, s[64:67], s22 offen offset:2048 sc1
    v_cvt_pk_bf16_f32 v109, v146, v147
    v_cvt_pk_bf16_f32 v110, v148, v149
    v_cvt_pk_bf16_f32 v111, v150, v151
    v_lshlrev_b32 v136, 16, v104
    v_and_b32 v137, s32, v104
    v_lshlrev_b32 v138, 16, v105
    v_and_b32 v139, s32, v105
    v_lshlrev_b32 v140, 16, v106
    v_and_b32 v141, s32, v106
    v_lshlrev_b32 v142, 16, v107
    v_and_b32 v143, s32, v107
    v_lshlrev_b32 v144, 16, v108
    v_and_b32 v145, s32, v108
    v_lshlrev_b32 v146, 16, v109
    buffer_load_dwordx4 a[152:155], v4, s[64:67], s22 offen offset:3072 sc1
    v_and_b32 v147, s32, v109
    v_lshlrev_b32_e64 v148, 16, v110
    v_and_b32_e64 v149, s32, v110
    v_lshlrev_b32_e64 v150, 16, v111
    v_and_b32_e64 v151, s32, v111
    v_cvt_pk_bf16_f32 v152, v152, v152
    v_and_b32 v152, s32, v152
    v_add_f32 v152, 0x358637bd, v152
    v_cvt_pk_bf16_f32 v152, v152, v152
    v_and_b32_e64 v152, s32, v152
    v_rcp_f32_e64 v152, v152
    s_nop 0
    v_pk_mul_f32 v[136:137], v[136:137], v[152:153] op_sel:[0,0] op_sel_hi:[1,0]
    v_pk_mul_f32 v[138:139], v[138:139], v[152:153] op_sel:[0,0] op_sel_hi:[1,0]
    v_pk_mul_f32 v[140:141], v[140:141], v[152:153] op_sel:[0,0] op_sel_hi:[1,0]
    buffer_load_dwordx4 a[156:159], v5, s[64:67], s22 offen offset:3072 sc1
    v_pk_mul_f32 v[142:143], v[142:143], v[152:153] op_sel:[0,0] op_sel_hi:[1,0]
    v_pk_mul_f32 v[144:145], v[144:145], v[152:153] op_sel:[0,0] op_sel_hi:[1,0]
    v_pk_mul_f32 v[146:147], v[146:147], v[152:153] op_sel:[0,0] op_sel_hi:[1,0]
    v_pk_mul_f32 v[148:149], v[148:149], v[152:153] op_sel:[0,0] op_sel_hi:[1,0]
    v_pk_mul_f32 v[150:151], v[150:151], v[152:153] op_sel:[0,0] op_sel_hi:[1,0]
    v_cvt_pk_bf16_f32 v104, v136, v137
    v_cvt_pk_bf16_f32 v105, v138, v139
    v_cvt_pk_bf16_f32 v106, v140, v141
    v_cvt_pk_bf16_f32 v107, v142, v143
    v_cvt_pk_bf16_f32 v108, v144, v145
    v_cvt_pk_bf16_f32 v109, v146, v147
    v_cvt_pk_bf16_f32 v110, v148, v149
    v_cvt_pk_bf16_f32 v111, v150, v151
    buffer_store_dwordx4 v[104:107], v34, s[64:67], s16 offen offset:0 sc1
    buffer_store_dwordx4 v[108:111], v34, s[64:67], s16 offen offset:1024 sc1
    s_waitcnt vmcnt(9)
    v_mfma_f32_32x32x16_bf16 v[64:79], a[0:3], a[128:131], 0
    v_mfma_f32_32x32x16_bf16 v[80:95], a[4:7], a[128:131], 0
    ds_read_b64_tr_b16 v[192:193], v36 offset:4096
    buffer_load_dwordx4 a[160:163], v4, s[64:67], s23 offen offset:0 sc1
    s_waitcnt vmcnt(9)
    v_mfma_f32_32x32x16_bf16 v[96:111], a[0:3], a[132:135], 0
    ds_read_b64_tr_b16 v[194:195], v36 offset:4608
    buffer_load_dwordx4 a[164:167], v5, s[64:67], s23 offen offset:0 sc1
    v_mfma_f32_32x32x16_bf16 v[112:127], a[4:7], a[132:135], 0
    ds_read_b64_tr_b16 v[196:197], v37 offset:4096
    buffer_load_dwordx4 a[168:171], v4, s[64:67], s23 offen offset:1024 sc1
    s_waitcnt vmcnt(10)
    v_mfma_f32_32x32x16_bf16 v[64:79], a[8:11], a[136:139], v[64:79]
    ds_read_b64_tr_b16 v[198:199], v37 offset:4608
    buffer_load_dwordx4 a[172:175], v5, s[64:67], s23 offen offset:1024 sc1
    v_mfma_f32_32x32x16_bf16 v[80:95], a[12:15], a[136:139], v[80:95]
    ds_read_b64_tr_b16 v[200:201], v36 offset:5120
    buffer_load_dwordx4 a[176:179], v4, s[64:67], s23 offen offset:2048 sc1
    s_waitcnt vmcnt(11)
    v_mfma_f32_32x32x16_bf16 v[96:111], a[8:11], a[140:143], v[96:111]
    ds_read_b64_tr_b16 v[202:203], v36 offset:5632
    buffer_load_dwordx4 a[180:183], v5, s[64:67], s23 offen offset:2048 sc1
    v_mfma_f32_32x32x16_bf16 v[112:127], a[12:15], a[140:143], v[112:127]
    ds_read_b64_tr_b16 v[204:205], v37 offset:5120
    s_waitcnt vmcnt(11)
    v_mfma_f32_32x32x16_bf16 v[64:79], a[16:19], a[144:147], v[64:79]
    ds_read_b64_tr_b16 v[206:207], v37 offset:5632
    v_mfma_f32_32x32x16_bf16 v[80:95], a[20:23], a[144:147], v[80:95]
    ds_read_b64_tr_b16 v[208:209], v36 offset:8192
    buffer_load_dwordx4 a[184:187], v4, s[64:67], s23 offen offset:3072 sc1
    s_waitcnt vmcnt(11)
    v_mfma_f32_32x32x16_bf16 v[96:111], a[16:19], a[148:151], v[96:111]
    ds_read_b64_tr_b16 v[210:211], v36 offset:8704
    buffer_load_dwordx4 a[188:191], v5, s[64:67], s23 offen offset:3072 sc1
    v_mfma_f32_32x32x16_bf16 v[112:127], a[20:23], a[148:151], v[112:127]
    ds_read_b64_tr_b16 v[212:213], v37 offset:8192
    s_waitcnt vmcnt(11)
    v_mfma_f32_32x32x16_bf16 v[64:79], a[24:27], a[152:155], v[64:79]
    s_waitcnt lgkmcnt(3)
    ds_read_b64_tr_b16 v[214:215], v37 offset:8704
    buffer_load_dwordx4 a[192:195], v4, s[64:67], s24 offen offset:0 sc1
    v_mfma_f32_32x32x16_bf16 v[80:95], a[28:31], a[152:155], v[80:95]
    ds_read_b64_tr_b16 v[216:217], v36 offset:9216
    s_waitcnt vmcnt(11)
    v_mfma_f32_32x32x16_bf16 v[96:111], a[24:27], a[156:159], v[96:111]
    ds_read_b64_tr_b16 v[218:219], v36 offset:9728
    buffer_load_dwordx4 a[196:199], v5, s[64:67], s24 offen offset:0 sc1
    v_mfma_f32_32x32x16_bf16 v[112:127], a[28:31], a[156:159], v[112:127]
    ds_read_b64_tr_b16 v[220:221], v37 offset:9216
    s_waitcnt vmcnt(9)
    v_mfma_f32_32x32x16_bf16 v[64:79], a[32:35], a[160:163], v[64:79]
    ds_read_b64_tr_b16 v[222:223], v37 offset:9728
    v_mfma_f32_32x32x16_bf16 v[80:95], a[36:39], a[160:163], v[80:95]
    ds_read_b64_tr_b16 v[224:225], v36 offset:12288
    buffer_load_dwordx4 a[200:203], v4, s[64:67], s24 offen offset:1024 sc1
    s_waitcnt vmcnt(9)
    v_mfma_f32_32x32x16_bf16 v[96:111], a[32:35], a[164:167], v[96:111]
    ds_read_b64_tr_b16 v[226:227], v36 offset:12800
    buffer_load_dwordx4 a[204:207], v5, s[64:67], s24 offen offset:1024 sc1
    v_mfma_f32_32x32x16_bf16 v[112:127], a[36:39], a[164:167], v[112:127]
    ds_read_b64_tr_b16 v[228:229], v37 offset:12288
    s_waitcnt vmcnt(9)
    v_mfma_f32_32x32x16_bf16 v[64:79], a[40:43], a[168:171], v[64:79]
    s_waitcnt lgkmcnt(3)
    ds_read_b64_tr_b16 v[230:231], v37 offset:12800
    buffer_load_dwordx4 a[208:211], v4, s[64:67], s24 offen offset:2048 sc1
    v_lshrrev_b32 v62, 3, v1
    v_lshlrev_b32_e64 v62, 2, v62
    ds_bpermute_b32 v8, v62, v40 offset:0
    ds_bpermute_b32 v9, v62, v40 offset:32
    v_mfma_f32_32x32x16_bf16 v[80:95], a[44:47], a[168:171], v[80:95]
    ds_read_b64_tr_b16 v[232:233], v36 offset:13312
    buffer_load_dwordx4 a[212:215], v5, s[64:67], s24 offen offset:2048 sc1
    ds_bpermute_b32 v20, v62, v40 offset:64
    ds_bpermute_b32 v21, v62, v40 offset:96
    v_lshlrev_b32 v22, 16, v14
    v_and_b32_e64 v23, s32, v14
    s_waitcnt vmcnt(10)
    v_mfma_f32_32x32x16_bf16 v[96:111], a[40:43], a[172:175], v[96:111]
    ds_read_b64_tr_b16 v[234:235], v36 offset:13824
    v_lshlrev_b32 v24, 16, v15
    v_and_b32 v25, s32, v15
    v_lshlrev_b32 v48, 16, v26
    v_and_b32 v49, s32, v26
    v_mfma_f32_32x32x16_bf16 v[112:127], a[44:47], a[172:175], v[112:127]
    ds_read_b64_tr_b16 v[236:237], v37 offset:13312
    buffer_load_dwordx4 a[216:219], v4, s[64:67], s24 offen offset:3072 sc1
    v_lshlrev_b32 v50, 16, v27
    v_and_b32 v51, s32, v27
    v_lshlrev_b32 v52, 16, v28
    v_and_b32 v53, s32, v28
    s_waitcnt vmcnt(10)
    v_mfma_f32_32x32x16_bf16 v[64:79], a[48:51], a[176:179], v[64:79]
    ds_read_b64_tr_b16 v[238:239], v37 offset:13824
    v_lshlrev_b32 v54, 16, v29
    v_and_b32 v55, s32, v29
    v_lshlrev_b32 v56, 16, v30
    buffer_load_dwordx4 a[220:223], v5, s[64:67], s24 offen offset:3072 sc1
    v_and_b32_e64 v57, s32, v30
    v_mfma_f32_32x32x16_bf16 v[80:95], a[52:55], a[176:179], v[80:95]
    ds_read_b64_tr_b16 v[240:241], v36 offset:0
    v_lshlrev_b32 v58, 16, v31
    v_and_b32 v59, s32, v31
    v_lshlrev_b32 v16, 16, v32
    v_and_b32 v17, s32, v32
    s_waitcnt vmcnt(10)
    v_mfma_f32_32x32x16_bf16 v[96:111], a[48:51], a[180:183], v[96:111]
    ds_read_b64_tr_b16 v[242:243], v36 offset:512
    v_lshlrev_b32 v18, 16, v33
    buffer_load_dwordx4 a[224:227], v4, s[64:67], s25 offen offset:0 sc1
    v_and_b32 v19, s32, v33
    v_mul_f32 v48, v48, v22
    v_mul_f32 v49, v49, v23
    v_mfma_f32_32x32x16_bf16 v[112:127], a[52:55], a[180:183], v[112:127]
    s_waitcnt lgkmcnt(2)
    ds_read_b64_tr_b16 v[244:245], v37 offset:0
    v_mul_f32 v50, v50, v24
    v_mul_f32 v51, v51, v25
    v_mul_f32 v52, v52, v22
    v_mul_f32_e64 v53, v53, v23
    s_waitcnt vmcnt(10)
    v_mfma_f32_32x32x16_bf16 v[64:79], a[56:59], a[184:187], v[64:79]
    ds_read_b64_tr_b16 v[246:247], v37 offset:512
    buffer_load_dwordx4 a[228:231], v5, s[64:67], s25 offen offset:0 sc1
    v_mul_f32 v54, v54, v24
    v_mul_f32 v55, v55, v25
    v_mul_f32_e64 v56, v56, v22
    v_mul_f32_e64 v57, v57, v23
    v_mfma_f32_32x32x16_bf16 v[80:95], a[60:63], a[184:187], v[80:95]
    ds_read_b64_tr_b16 v[248:249], v36 offset:1024
    v_mul_f32_e64 v58, v58, v24
    v_mul_f32_e64 v59, v59, v25
    v_mul_f32 v16, v16, v22
    v_mul_f32_e64 v17, v17, v23
    s_waitcnt vmcnt(10)
    v_mfma_f32_32x32x16_bf16 v[96:111], a[56:59], a[188:191], v[96:111]
    ds_read_b64_tr_b16 v[250:251], v36 offset:1536
    buffer_load_dwordx4 a[232:235], v4, s[64:67], s25 offen offset:1024 sc1
    v_mul_f32_e64 v18, v18, v24
    v_mul_f32_e64 v19, v19, v25
    v_cvt_pk_bf16_f32 v26, v48, v49
    v_cvt_pk_bf16_f32 v27, v50, v51
    v_mfma_f32_32x32x16_bf16 v[112:127], a[60:63], a[188:191], v[112:127]
    ds_read_b64_tr_b16 v[252:253], v37 offset:1024
    v_cvt_pk_bf16_f32 v28, v52, v53
    v_cvt_pk_bf16_f32 v29, v54, v55
    v_cvt_pk_bf16_f32 v30, v56, v57
    buffer_load_dwordx4 a[236:239], v5, s[64:67], s25 offen offset:1024 sc1
    v_cvt_pk_bf16_f32 v31, v58, v59
    s_waitcnt vmcnt(11)
    v_mfma_f32_32x32x16_bf16 v[64:79], a[64:67], a[192:195], v[64:79]
    ds_read_b64_tr_b16 v[254:255], v37 offset:1536
    v_cvt_pk_bf16_f32 v32, v16, v17
    v_cvt_pk_bf16_f32 v33, v18, v19
    v_sub_f32 v38, 1.0, v8
    v_sub_f32 v39, 1.0, v9
    v_mfma_f32_32x32x16_bf16 v[80:95], a[68:71], a[192:195], v[80:95]
    v_sub_f32 v46, 1.0, v20
    v_sub_f32_e64 v47, 1.0, v21
    v_cvt_pk_bf16_f32 v38, v38, v38
    v_cvt_pk_bf16_f32 v39, v39, v39
    buffer_load_dwordx4 a[240:243], v4, s[64:67], s25 offen offset:2048 sc1
    s_waitcnt vmcnt(11)
    v_mfma_f32_32x32x16_bf16 v[96:111], a[64:67], a[196:199], v[96:111]
    v_cvt_pk_bf16_f32 v46, v46, v46
    v_cvt_pk_bf16_f32 v47, v47, v47
    v_and_b32 v38, s32, v38
    v_and_b32_e64 v39, s32, v39
    v_mfma_f32_32x32x16_bf16 v[112:127], a[68:71], a[196:199], v[112:127]
    v_and_b32 v46, s32, v46
    v_and_b32 v47, s32, v47
    s_waitcnt lgkmcnt(0)
    v_lshlrev_b32 v48, 16, v26
    v_and_b32 v49, s32, v26
    buffer_load_dwordx4 a[244:247], v5, s[64:67], s25 offen offset:2048 sc1
    s_waitcnt vmcnt(11)
    v_mfma_f32_32x32x16_bf16 v[64:79], a[72:75], a[200:203], v[64:79]
    v_lshlrev_b32 v50, 16, v27
    v_and_b32 v51, s32, v27
    v_lshlrev_b32 v52, 16, v28
    v_and_b32 v53, s32, v28
    v_mfma_f32_32x32x16_bf16 v[80:95], a[76:79], a[200:203], v[80:95]
    v_lshlrev_b32 v54, 16, v29
    v_and_b32 v55, s32, v29
    v_lshlrev_b32 v56, 16, v30
    v_and_b32 v57, s32, v30
    buffer_load_dwordx4 a[248:251], v4, s[64:67], s25 offen offset:3072 sc1
    s_waitcnt vmcnt(11)
    v_mfma_f32_32x32x16_bf16 v[96:111], a[72:75], a[204:207], v[96:111]
    v_lshlrev_b32 v58, 16, v31
    v_and_b32 v59, s32, v31
    v_lshlrev_b32 v16, 16, v32
    v_and_b32_e64 v17, s32, v32
    v_mfma_f32_32x32x16_bf16 v[112:127], a[76:79], a[204:207], v[112:127]
    v_lshlrev_b32 v18, 16, v33
    v_and_b32 v19, s32, v33
    v_mul_f32 v48, v48, v38
    v_mul_f32 v49, v49, v38
    buffer_load_dwordx4 a[252:255], v5, s[64:67], s25 offen offset:3072 sc1
    s_waitcnt vmcnt(11)
    v_mfma_f32_32x32x16_bf16 v[64:79], a[80:83], a[208:211], v[64:79]
    v_mul_f32 v50, v50, v38
    v_mul_f32 v51, v51, v38
    v_mul_f32 v52, v52, v39
    v_mul_f32_e64 v53, v53, v39
    v_mfma_f32_32x32x16_bf16 v[80:95], a[84:87], a[208:211], v[80:95]
    v_mul_f32 v54, v54, v39
    v_mul_f32 v55, v55, v39
    v_mul_f32 v56, v56, v46
    v_mul_f32 v57, v57, v46
    buffer_load_dwordx4 v[128:131], v6, s[64:67], s22 offen offset:0 sc1
    s_waitcnt vmcnt(11)
    v_mfma_f32_32x32x16_bf16 v[96:111], a[80:83], a[212:215], v[96:111]
    v_mul_f32 v58, v58, v46
    v_mul_f32_e64 v59, v59, v46
    v_mul_f32_e64 v16, v16, v47
    v_mul_f32_e64 v17, v17, v47
    v_mfma_f32_32x32x16_bf16 v[112:127], a[84:87], a[212:215], v[112:127]
    v_mul_f32_e64 v18, v18, v47
    v_mul_f32_e64 v19, v19, v47
    s_waitcnt vmcnt(10)
    v_mfma_f32_32x32x16_bf16 v[64:79], a[88:91], a[216:219], v[64:79]
    buffer_load_dwordx4 v[136:139], v6, s[64:67], s22 offen offset:1024 sc1
    v_mfma_f32_32x32x16_bf16 v[80:95], a[92:95], a[216:219], v[80:95]
    s_waitcnt vmcnt(10)
    v_mfma_f32_32x32x16_bf16 v[96:111], a[88:91], a[220:223], v[96:111]
    buffer_load_dwordx4 v[144:147], v6, s[64:67], s23 offen offset:0 sc1
    v_mfma_f32_32x32x16_bf16 v[112:127], a[92:95], a[220:223], v[112:127]
    s_waitcnt vmcnt(10)
    v_mfma_f32_32x32x16_bf16 v[64:79], a[96:99], a[224:227], v[64:79]
    buffer_load_dwordx4 v[152:155], v6, s[64:67], s23 offen offset:1024 sc1
    s_waitcnt vmcnt(9)
    v_mfma_f32_32x32x16_bf16 v[64:79], a[104:107], a[232:235], v[64:79]
    buffer_load_dwordx4 v[132:135], v7, s[64:67], s22 offen offset:0 sc1
    s_waitcnt vmcnt(8)
    v_mfma_f32_32x32x16_bf16 v[64:79], a[112:115], a[240:243], v[64:79]
    buffer_load_dwordx4 v[140:143], v7, s[64:67], s22 offen offset:1024 sc1
    buffer_load_dwordx4 v[148:151], v7, s[64:67], s23 offen offset:0 sc1
    s_waitcnt vmcnt(8)
    v_mfma_f32_32x32x16_bf16 v[64:79], a[120:123], a[248:251], v[64:79]
    buffer_load_dwordx4 v[156:159], v7, s[64:67], s23 offen offset:1024 sc1
    v_mfma_f32_32x32x16_bf16 v[80:95], a[100:103], a[224:227], v[80:95]
    buffer_load_dwordx4 v[164:167], v7, s[64:67], s24 offen offset:0 sc1
    v_mfma_f32_32x32x16_bf16 v[80:95], a[108:111], a[232:235], v[80:95]
    buffer_load_dwordx4 v[172:175], v7, s[64:67], s24 offen offset:1024 sc1
    v_mfma_f32_32x32x16_bf16 v[80:95], a[116:119], a[240:243], v[80:95]
    v_mfma_f32_32x32x16_bf16 v[80:95], a[124:127], a[248:251], v[80:95]
    v_mfma_f32_32x32x16_bf16 v[96:111], a[96:99], a[228:231], v[96:111]
    s_nop 3
    v_mul_f32 v64, v42, v64
    v_mul_f32 v65, v42, v65
    v_mul_f32 v66, v42, v66
    v_mul_f32_e64 v67, v42, v67
    v_mfma_f32_32x32x16_bf16 v[96:111], a[104:107], a[236:239], v[96:111]
    v_mul_f32 v68, v42, v68
    v_mul_f32 v69, v42, v69
    v_mul_f32 v70, v42, v70
    v_mul_f32 v71, v42, v71
    v_mfma_f32_32x32x16_bf16 v[96:111], a[112:115], a[244:247], v[96:111]
    v_mul_f32 v72, v42, v72
    v_mul_f32 v73, v42, v73
    v_mul_f32 v74, v42, v74
    v_mul_f32 v75, v42, v75
    s_waitcnt vmcnt(10)
    v_mfma_f32_32x32x16_bf16 v[96:111], a[120:123], a[252:255], v[96:111]
    v_mul_f32 v76, v42, v76
    v_mul_f32 v77, v42, v77
    v_mul_f32 v78, v42, v78
    v_mul_f32 v79, v42, v79
    v_mfma_f32_32x32x16_bf16 v[112:127], a[100:103], a[228:231], v[112:127]
    v_mul_f32 v80, v42, v80
    v_mul_f32 v81, v42, v81
    v_mul_f32 v82, v42, v82
    v_mul_f32 v83, v42, v83
    v_mfma_f32_32x32x16_bf16 v[112:127], a[108:111], a[236:239], v[112:127]
    buffer_load_dwordx4 v[180:183], v7, s[64:67], s25 offen offset:0 sc1
    v_mul_f32 v84, v42, v84
    v_mul_f32 v85, v42, v85
    v_mul_f32 v86, v42, v86
    v_mul_f32 v87, v42, v87
    v_mfma_f32_32x32x16_bf16 v[112:127], a[116:119], a[244:247], v[112:127]
    v_mul_f32 v88, v42, v88
    v_mul_f32 v89, v42, v89
    v_mul_f32 v90, v42, v90
    v_mul_f32 v91, v42, v91
    v_mfma_f32_32x32x16_bf16 v[112:127], a[124:127], a[252:255], v[112:127]
    buffer_load_dwordx4 v[188:191], v7, s[64:67], s25 offen offset:1024 sc1
    v_mul_f32 v92, v42, v92
    v_mul_f32 v93, v42, v93
    v_mul_f32 v94, v42, v94
    v_mul_f32 v95, v42, v95
    s_waitcnt vmcnt(9)
    v_max3_u32 v3, v128, v136, v144
    buffer_load_dwordx4 v[160:163], v6, s[64:67], s24 offen offset:0 sc1
    s_waitcnt vmcnt(8)
    v_max3_u32 v3, v3, v152, v132
    buffer_load_dwordx4 v[168:171], v6, s[64:67], s24 offen offset:1024 sc1
    buffer_load_dwordx4 v[176:179], v6, s[64:67], s25 offen offset:0 sc1
    s_waitcnt vmcnt(8)
    v_max3_u32 v3, v3, v140, v148
    buffer_load_dwordx4 v[184:187], v6, s[64:67], s25 offen offset:1024 sc1
    s_waitcnt vmcnt(8)
    v_max_u32 v3, v3, v156
    v_cmp_eq_u32 vcc, -1, v3
    s_cbranch_vccnz L_slow_o1
L_back_o1:
    v_mfma_f32_32x32x16_bf16 v[64:79], v[192:195], v[128:131], v[64:79]
    v_mul_f32 v96, v44, v96
    v_mul_f32 v97, v44, v97
    v_mul_f32 v98, v44, v98
    v_mul_f32 v99, v44, v99
    v_mfma_f32_32x32x16_bf16 v[80:95], v[196:199], v[128:131], v[80:95]
    v_mul_f32 v100, v44, v100
    v_mul_f32 v101, v44, v101
    v_mul_f32 v102, v44, v102
    v_mul_f32 v103, v44, v103
    v_mfma_f32_32x32x16_bf16 v[64:79], v[200:203], v[136:139], v[64:79]
    v_mul_f32 v104, v44, v104
    v_mul_f32 v105, v44, v105
    v_mul_f32 v106, v44, v106
    v_mul_f32 v107, v44, v107
    v_mfma_f32_32x32x16_bf16 v[80:95], v[204:207], v[136:139], v[80:95]
    v_mul_f32 v108, v44, v108
    v_mul_f32 v109, v44, v109
    v_mul_f32 v110, v44, v110
    v_mul_f32 v111, v44, v111
    v_mfma_f32_32x32x16_bf16 v[64:79], v[208:211], v[144:147], v[64:79]
    v_mul_f32 v112, v44, v112
    v_mul_f32 v113, v44, v113
    v_mul_f32 v114, v44, v114
    v_mul_f32 v115, v44, v115
    v_mfma_f32_32x32x16_bf16 v[80:95], v[212:215], v[144:147], v[80:95]
    v_mul_f32 v116, v44, v116
    v_mul_f32 v117, v44, v117
    v_mul_f32 v118, v44, v118
    v_mul_f32 v119, v44, v119
    v_mfma_f32_32x32x16_bf16 v[64:79], v[216:219], v[152:155], v[64:79]
    v_mul_f32 v120, v44, v120
    v_mul_f32 v121, v44, v121
    v_mul_f32 v122, v44, v122
    v_mul_f32 v123, v44, v123
    v_mfma_f32_32x32x16_bf16 v[80:95], v[220:223], v[152:155], v[80:95]
    v_mul_f32 v124, v44, v124
    v_mul_f32 v125, v44, v125
    v_mul_f32 v126, v44, v126
    v_mul_f32 v127, v44, v127
    v_mfma_f32_32x32x16_bf16 v[96:111], v[192:195], v[132:135], v[96:111]
    s_nop 0
    v_mfma_f32_32x32x16_bf16 v[112:127], v[196:199], v[132:135], v[112:127]
    v_mfma_f32_32x32x16_bf16 v[96:111], v[200:203], v[140:143], v[96:111]
    v_mfma_f32_32x32x16_bf16 v[112:127], v[204:207], v[140:143], v[112:127]
    v_mfma_f32_32x32x16_bf16 v[96:111], v[208:211], v[148:151], v[96:111]
    s_waitcnt vmcnt(5)
    v_max3_u32 v3, v164, v172, v180
    s_waitcnt vmcnt(3)
    v_max3_u32 v3, v3, v188, v160
    v_mfma_f32_32x32x16_bf16 v[112:127], v[212:215], v[148:151], v[112:127]
    s_waitcnt vmcnt(1)
    v_max3_u32 v3, v3, v168, v176
    s_waitcnt vmcnt(0)
    v_max_u32 v3, v3, v184
    v_mfma_f32_32x32x16_bf16 v[96:111], v[216:219], v[156:159], v[96:111]
    v_cmp_eq_u32_e64 vcc, -1, v3
    v_mfma_f32_32x32x16_bf16 v[112:127], v[220:223], v[156:159], v[112:127]
    s_cbranch_vccnz L_slow_o2
L_back_o2:
    v_mfma_f32_32x32x16_bf16 v[96:111], v[224:227], v[164:167], v[96:111]
    v_mfma_f32_32x32x16_bf16 v[96:111], v[232:235], v[172:175], v[96:111]
    v_mfma_f32_32x32x16_bf16 v[96:111], v[240:243], v[180:183], v[96:111]
    v_mfma_f32_32x32x16_bf16 v[96:111], v[248:251], v[188:191], v[96:111]
    v_mfma_f32_32x32x16_bf16 v[112:127], v[228:231], v[164:167], v[112:127]
    s_lshl_b32 s98, s90, 12
    v_and_b32 v62, 7, v1
    v_xor_b32 v14, v62, v2
    v_mfma_f32_32x32x16_bf16 v[112:127], v[236:239], v[172:175], v[112:127]
    v_and_b32 v15, 31, v1
    v_lshl_add_u32 v15, v15, 7, s98
    v_lshl_or_b32 v14, v14, 4, v15
    v_mfma_f32_32x32x16_bf16 v[112:127], v[244:247], v[180:183], v[112:127]
    v_xor_b32 v15, 32, v14
    v_xor_b32_e64 v22, 64, v14
    v_xor_b32 v23, 0x60, v14
    v_mfma_f32_32x32x16_bf16 v[112:127], v[252:255], v[188:191], v[112:127]
    v_mfma_f32_32x32x16_bf16 v[80:95], v[228:231], v[160:163], v[80:95]
    ds_write_b128 v14, v[96:99] offset:32768
    v_mfma_f32_32x32x16_bf16 v[80:95], v[236:239], v[168:171], v[80:95]
    ds_write_b128 v15, v[100:103] offset:32768
    v_mfma_f32_32x32x16_bf16 v[80:95], v[244:247], v[176:179], v[80:95]
    ds_write_b128 v22, v[104:107] offset:32768
    v_mfma_f32_32x32x16_bf16 v[80:95], v[252:255], v[184:187], v[80:95]
    ds_write_b128 v23, v[108:111] offset:32768
    v_mfma_f32_32x32x16_bf16 v[64:79], v[224:227], v[160:163], v[64:79]
    v_lshrrev_b32 v28, 3, v1
    v_xor_b32 v62, v62, v28
    v_lshl_add_u32 v27, v28, 7, s98
    ds_write_b128 v14, v[112:115] offset:49152
    ds_write_b128 v15, v[116:119] offset:49152
    v_mfma_f32_32x32x16_bf16 v[64:79], v[232:235], v[168:171], v[64:79]
    ds_write_b128 v22, v[120:123] offset:49152
    ds_write_b128 v23, v[124:127] offset:49152
    v_mfma_f32_32x32x16_bf16 v[64:79], v[240:243], v[176:179], v[64:79]
    v_lshl_or_b32 v26, v62, 4, v27
    v_xor_b32 v27, 4096, v26
    ds_write_b128 v14, v[80:83] offset:16384
    ds_write_b128 v15, v[84:87] offset:16384
    v_mfma_f32_32x32x16_bf16 v[64:79], v[248:251], v[184:187], v[64:79]
    ds_write_b128 v22, v[88:91] offset:16384
    ds_write_b128 v23, v[92:95] offset:16384
    v_xor_b32 v28, 8192, v26
    v_xor_b32 v29, 12288, v26
    v_lshlrev_b32 v11, 1, v11
    s_mov_b32 s81, 32768
    s_mov_b32 s82, 49152
    s_or_b32 s3, s2, s90
    v_mov_b32 v3, 0
    s_nop 2
    ds_write_b128 v14, v[64:67] offset:0
    ds_write_b128 v15, v[68:71] offset:0
    ds_write_b128 v22, v[72:75] offset:0
    ds_write_b128 v23, v[76:79] offset:0
    s_waitcnt lgkmcnt(0)
    s_barrier
    ds_read_b128 v[128:131], v26 offset:0
    ds_read_b128 v[132:135], v27 offset:16384
    ds_read_b128 v[136:139], v28 offset:32768
    ds_read_b128 v[140:143], v29 offset:49152
    ds_read_b128 v[144:147], v26 offset:1024
    ds_read_b128 v[148:151], v27 offset:17408
    ds_read_b128 v[152:155], v28 offset:33792
    ds_read_b128 v[156:159], v29 offset:50176
    ds_read_b128 v[160:163], v26 offset:2048
    ds_read_b128 v[164:167], v27 offset:18432
    ds_read_b128 v[168:171], v28 offset:34816
    ds_read_b128 v[172:175], v29 offset:51200
    ds_read_b128 v[176:179], v26 offset:3072
    ds_read_b128 v[180:183], v27 offset:19456
    ds_read_b128 v[184:187], v28 offset:35840
    ds_read_b128 v[188:191], v29 offset:52224
    s_waitcnt lgkmcnt(7)
    v_pk_add_f32 v[128:129], v[128:129], v[132:133]
    v_pk_add_f32 v[136:137], v[136:137], v[140:141]
    v_pk_add_f32 v[130:131], v[130:131], v[134:135]
    v_pk_add_f32 v[138:139], v[138:139], v[142:143]
    v_pk_add_f32 v[128:129], v[128:129], v[136:137]
    v_pk_add_f32 v[130:131], v[130:131], v[138:139]
    v_pk_fma_f32 v[128:129], v[128:129], v[8:9], v[48:49] op_sel:[0,0,0] op_sel_hi:[1,0,1]
    v_pk_fma_f32 v[130:131], v[130:131], v[8:9], v[50:51] op_sel:[0,0,0] op_sel_hi:[1,0,1]
    buffer_store_dwordx4 v[128:131], v11, s[68:71], 0 offen sc1
    v_pk_add_f32 v[144:145], v[144:145], v[148:149]
    v_pk_add_f32 v[152:153], v[152:153], v[156:157]
    v_pk_add_f32 v[146:147], v[146:147], v[150:151]
    v_pk_add_f32 v[154:155], v[154:155], v[158:159]
    v_pk_add_f32 v[144:145], v[144:145], v[152:153]
    v_pk_add_f32 v[146:147], v[146:147], v[154:155]
    v_pk_fma_f32 v[144:145], v[144:145], v[8:9], v[52:53] op_sel:[0,1,0] op_sel_hi:[1,1,1]
    v_pk_fma_f32 v[146:147], v[146:147], v[8:9], v[54:55] op_sel:[0,1,0] op_sel_hi:[1,1,1]
    buffer_store_dwordx4 v[144:147], v11, s[68:71], s79 offen sc1
    s_waitcnt lgkmcnt(2)
    v_pk_add_f32 v[160:161], v[160:161], v[164:165]
    v_pk_add_f32 v[168:169], v[168:169], v[172:173]
    v_pk_add_f32 v[162:163], v[162:163], v[166:167]
    v_pk_add_f32 v[170:171], v[170:171], v[174:175]
    v_pk_add_f32 v[160:161], v[160:161], v[168:169]
    v_pk_add_f32 v[162:163], v[162:163], v[170:171]
    v_pk_fma_f32 v[160:161], v[160:161], v[20:21], v[56:57] op_sel:[0,0,0] op_sel_hi:[1,0,1]
    v_pk_fma_f32 v[162:163], v[162:163], v[20:21], v[58:59] op_sel:[0,0,0] op_sel_hi:[1,0,1]
    buffer_store_dwordx4 v[160:163], v11, s[68:71], s81 offen sc1
    v_pk_add_f32 v[176:177], v[176:177], v[180:181]
    s_waitcnt lgkmcnt(0)
    v_pk_add_f32 v[184:185], v[184:185], v[188:189]
    v_pk_add_f32 v[178:179], v[178:179], v[182:183]
    v_pk_add_f32 v[186:187], v[186:187], v[190:191]
    v_pk_add_f32 v[176:177], v[176:177], v[184:185]
    v_pk_add_f32 v[178:179], v[178:179], v[186:187]
    v_pk_fma_f32 v[176:177], v[176:177], v[20:21], v[16:17] op_sel:[0,1,0] op_sel_hi:[1,1,1]
    v_pk_fma_f32 v[178:179], v[178:179], v[20:21], v[18:19] op_sel:[0,1,0] op_sel_hi:[1,1,1]
    buffer_store_dwordx4 v[176:179], v11, s[68:71], s82 offen sc1
    s_cmp_lg_u32 s3, 0
    s_cbranch_scc1 L_end
    s_mov_b64 exec, 1
    buffer_store_dword v60, v3, s[64:67], 0 offen sc1
L_end:
    s_endpgm
L_code_end:
L_slow_e:
    s_mov_b32 s99, 4096
L_loop_e:
    s_nop 4
    buffer_load_dwordx2 v[224:225], v10, s[64:67], s36 offen offset:256 sc1
    buffer_load_dwordx2 v[226:227], v10, s[64:67], s36 offen offset:768 sc1
    buffer_load_dwordx2 v[228:229], v10, s[64:67], s36 offen offset:1280 sc1
    buffer_load_dwordx2 v[230:231], v10, s[64:67], s36 offen offset:1792 sc1
    buffer_load_dwordx2 v[232:233], v10, s[64:67], s36 offen offset:2304 sc1
    buffer_load_dwordx2 v[234:235], v10, s[64:67], s36 offen offset:2816 sc1
    buffer_load_dwordx2 v[236:237], v10, s[64:67], s36 offen offset:3328 sc1
    buffer_load_dwordx2 v[238:239], v10, s[64:67], s36 offen offset:3840 sc1
    s_waitcnt vmcnt(0)
    v_bitop3_b32 v224, v224, v60, s97 bitop3:0x78
    v_bitop3_b32 v226, v226, v60, s97 bitop3:0x78
    v_bitop3_b32 v228, v228, v60, s97 bitop3:0x78
    v_bitop3_b32 v230, v230, v60, s97 bitop3:0x78
    v_bitop3_b32 v232, v232, v60, s97 bitop3:0x78
    v_bitop3_b32 v234, v234, v60, s97 bitop3:0x78
    v_bitop3_b32 v236, v236, v60, s97 bitop3:0x78
    v_bitop3_b32 v238, v238, v60, s97 bitop3:0x78
    v_or3_b32 v3, v224, v226, v228
    v_or3_b32 v3, v3, v230, v232
    v_or3_b32 v3, v3, v234, v236
    v_bitop3_b32 v3, v3, v238, s97 bitop3:0xa8
    v_cmp_ne_u32 vcc, 0, v3
    s_nop 4
    s_cbranch_vccz L_back_e
    s_sub_u32 s99, s99, 1
    s_cbranch_scc0 L_loop_e
    s_branch L_back_e
L_slow_kv:
    s_mov_b32 s99, 4096
L_loop_kv:
    s_nop 4
    buffer_load_dwordx4 v[96:99], v61, s[64:67], s72 offen offset:0 sc1
    buffer_load_dwordx4 v[100:103], v61, s[64:67], s72 offen offset:1024 sc1
    buffer_load_dwordx4 v[104:107], v61, s[64:67], s72 offen offset:2048 sc1
    buffer_load_dwordx4 v[108:111], v61, s[64:67], s72 offen offset:3072 sc1
    buffer_load_dwordx4 v[112:115], v61, s[64:67], s73 offen offset:0 sc1
    buffer_load_dwordx4 v[116:119], v61, s[64:67], s73 offen offset:1024 sc1
    buffer_load_dwordx4 v[120:123], v61, s[64:67], s73 offen offset:2048 sc1
    buffer_load_dwordx4 v[124:127], v61, s[64:67], s73 offen offset:3072 sc1
    buffer_load_dwordx4 v[128:131], v61, s[64:67], s74 offen offset:0 sc1
    buffer_load_dwordx4 v[132:135], v61, s[64:67], s74 offen offset:1024 sc1
    buffer_load_dwordx4 v[136:139], v61, s[64:67], s74 offen offset:2048 sc1
    buffer_load_dwordx4 v[140:143], v61, s[64:67], s74 offen offset:3072 sc1
    buffer_load_dwordx4 v[144:147], v61, s[64:67], s75 offen offset:0 sc1
    buffer_load_dwordx4 v[148:151], v61, s[64:67], s75 offen offset:1024 sc1
    buffer_load_dwordx4 v[152:155], v61, s[64:67], s75 offen offset:2048 sc1
    buffer_load_dwordx4 v[156:159], v61, s[64:67], s75 offen offset:3072 sc1
    buffer_load_dwordx4 v[160:163], v61, s[64:67], s9 offen sc1
    s_waitcnt vmcnt(0)
    v_bitop3_b32 v160, v160, v60, s97 bitop3:0x78
    v_bitop3_b32 v96, v96, v60, s97 bitop3:0x78
    v_bitop3_b32 v100, v100, v60, s97 bitop3:0x78
    v_or3_b32 v3, v160, v96, v100
    v_pk_add_f32 v[96:97], v[96:97], v[100:101]
    v_pk_add_f32 v[98:99], v[98:99], v[102:103]
    v_bitop3_b32 v104, v104, v60, s97 bitop3:0x78
    v_bitop3_b32 v108, v108, v60, s97 bitop3:0x78
    v_or3_b32 v3, v3, v104, v108
    v_pk_add_f32 v[104:105], v[104:105], v[108:109]
    v_pk_add_f32 v[106:107], v[106:107], v[110:111]
    v_pk_add_f32 v[96:97], v[96:97], v[104:105]
    v_pk_add_f32 v[98:99], v[98:99], v[106:107]
    v_bitop3_b32 v112, v112, v60, s97 bitop3:0x78
    v_bitop3_b32 v116, v116, v60, s97 bitop3:0x78
    v_or3_b32 v3, v3, v112, v116
    v_pk_add_f32 v[112:113], v[112:113], v[116:117]
    v_pk_add_f32 v[114:115], v[114:115], v[118:119]
    v_pk_add_f32 v[96:97], v[96:97], v[112:113]
    v_pk_add_f32 v[98:99], v[98:99], v[114:115]
    v_bitop3_b32 v120, v120, v60, s97 bitop3:0x78
    v_bitop3_b32 v124, v124, v60, s97 bitop3:0x78
    v_or3_b32 v3, v3, v120, v124
    v_pk_add_f32 v[120:121], v[120:121], v[124:125]
    v_pk_add_f32 v[122:123], v[122:123], v[126:127]
    v_pk_add_f32 v[96:97], v[96:97], v[120:121]
    v_pk_add_f32 v[98:99], v[98:99], v[122:123]
    v_bitop3_b32 v128, v128, v60, s97 bitop3:0x78
    v_bitop3_b32 v132, v132, v60, s97 bitop3:0x78
    v_or3_b32 v3, v3, v128, v132
    v_pk_add_f32 v[128:129], v[128:129], v[132:133]
    v_pk_add_f32 v[130:131], v[130:131], v[134:135]
    v_pk_add_f32 v[96:97], v[96:97], v[128:129]
    v_pk_add_f32 v[98:99], v[98:99], v[130:131]
    v_bitop3_b32 v136, v136, v60, s97 bitop3:0x78
    v_bitop3_b32 v140, v140, v60, s97 bitop3:0x78
    v_or3_b32 v3, v3, v136, v140
    v_pk_add_f32 v[136:137], v[136:137], v[140:141]
    v_pk_add_f32 v[138:139], v[138:139], v[142:143]
    v_pk_add_f32 v[96:97], v[96:97], v[136:137]
    v_pk_add_f32 v[98:99], v[98:99], v[138:139]
    v_bitop3_b32 v144, v144, v60, s97 bitop3:0x78
    v_bitop3_b32 v148, v148, v60, s97 bitop3:0x78
    v_or3_b32 v3, v3, v144, v148
    v_pk_add_f32 v[144:145], v[144:145], v[148:149]
    v_pk_add_f32 v[146:147], v[146:147], v[150:151]
    v_pk_add_f32 v[96:97], v[96:97], v[144:145]
    v_pk_add_f32 v[98:99], v[98:99], v[146:147]
    v_bitop3_b32 v152, v152, v60, s97 bitop3:0x78
    v_bitop3_b32 v156, v156, v60, s97 bitop3:0x78
    v_or3_b32 v3, v3, v152, v156
    v_and_b32 v3, s97, v3
    v_cmp_ne_u32 vcc, 0, v3
    v_pk_add_f32 v[152:153], v[152:153], v[156:157]
    v_pk_add_f32 v[154:155], v[154:155], v[158:159]
    v_pk_add_f32 v[96:97], v[96:97], v[152:153]
    v_pk_add_f32 v[98:99], v[98:99], v[154:155]
    s_nop 4
    s_cbranch_vccz L_back_kv
    s_sub_u32 s99, s99, 1
    s_cbranch_scc0 L_loop_kv
    s_branch L_back_kv
L_slow_fh:
    s_mov_b32 s99, 4096
L_loop_fh:
    s_nop 4
    buffer_load_dword v22, v35, s[64:67], s14 offen sc1
    s_waitcnt vmcnt(0)
    v_cmp_ne_u32 vcc, s91, v22
    s_nop 4
    s_cbranch_vccz L_back_fh
    s_sub_u32 s99, s99, 1
    s_cbranch_scc0 L_loop_fh
    s_branch L_back_fh
L_slow_g:
    s_mov_b32 s99, 4096
L_loop_g:
    s_nop 4
    buffer_load_dword v40, v38, s[64:67], 0 offen sc1
    buffer_load_dword v41, v39, s[64:67], 0 offen sc1
    s_waitcnt vmcnt(0)
    v_xor_b32 v3, v60, v40
    v_bitop3_b32 v3, v41, v60, v3 bitop3:0xbe
    v_and_b32 v3, s33, v3
    v_cmp_ne_u32 vcc, 0, v3
    s_nop 4
    s_cbranch_vccz L_back_g
    s_sub_u32 s99, s99, 1
    s_cbranch_scc0 L_loop_g
    s_branch L_back_g
L_slow_o1:
    s_mov_b32 s99, 4096
L_loop_o1:
    s_nop 4
    buffer_load_dwordx4 v[128:131], v6, s[64:67], s22 offen offset:0 sc1
    buffer_load_dwordx4 v[136:139], v6, s[64:67], s22 offen offset:1024 sc1
    buffer_load_dwordx4 v[144:147], v6, s[64:67], s23 offen offset:0 sc1
    buffer_load_dwordx4 v[152:155], v6, s[64:67], s23 offen offset:1024 sc1
    buffer_load_dwordx4 v[132:135], v7, s[64:67], s22 offen offset:0 sc1
    buffer_load_dwordx4 v[140:143], v7, s[64:67], s22 offen offset:1024 sc1
    buffer_load_dwordx4 v[148:151], v7, s[64:67], s23 offen offset:0 sc1
    buffer_load_dwordx4 v[156:159], v7, s[64:67], s23 offen offset:1024 sc1
    s_waitcnt vmcnt(0)
    v_max3_u32 v3, v128, v136, v144
    v_max3_u32 v3, v3, v152, v132
    v_max3_u32 v3, v3, v140, v148
    v_max_u32 v3, v3, v156
    v_cmp_eq_u32 vcc, -1, v3
    s_nop 4
    s_cbranch_vccz L_back_o1
    s_sub_u32 s99, s99, 1
    s_cbranch_scc0 L_loop_o1
    s_branch L_back_o1
L_slow_o2:
    s_mov_b32 s99, 4096
L_loop_o2:
    s_nop 4
    buffer_load_dwordx4 v[164:167], v7, s[64:67], s24 offen offset:0 sc1
    buffer_load_dwordx4 v[172:175], v7, s[64:67], s24 offen offset:1024 sc1
    buffer_load_dwordx4 v[180:183], v7, s[64:67], s25 offen offset:0 sc1
    buffer_load_dwordx4 v[188:191], v7, s[64:67], s25 offen offset:1024 sc1
    buffer_load_dwordx4 v[160:163], v6, s[64:67], s24 offen offset:0 sc1
    buffer_load_dwordx4 v[168:171], v6, s[64:67], s24 offen offset:1024 sc1
    buffer_load_dwordx4 v[176:179], v6, s[64:67], s25 offen offset:0 sc1
    buffer_load_dwordx4 v[184:187], v6, s[64:67], s25 offen offset:1024 sc1
    s_waitcnt vmcnt(0)
    v_max3_u32 v3, v164, v172, v180
    v_max3_u32 v3, v3, v188, v160
    v_max3_u32 v3, v3, v168, v176
    v_max_u32 v3, v3, v184
    v_cmp_eq_u32 vcc, -1, v3
    s_nop 4
    s_cbranch_vccz L_back_o2
    s_sub_u32 s99, s99, 1
    s_cbranch_scc0 L_loop_o2
    s_branch L_back_o2
L_z0:
L_z1:
.section .rodata,"a"
.p2align 6
.amdhsa_kernel gated_mix__linear_kernel_hedgehog__ssm_conv_s5__prompt_kernel
  .amdhsa_next_free_vgpr 512
  .amdhsa_next_free_sgpr 102
  .amdhsa_accum_offset 256
  .amdhsa_group_segment_fixed_size 0
  .amdhsa_kernarg_size 136
  .amdhsa_user_sgpr_count 2
  .amdhsa_user_sgpr_kernarg_segment_ptr 1
  .amdhsa_system_sgpr_workgroup_id_x 1
.end_amdhsa_kernel
```
